```python
import torch

def _softmax(x, axis=-1):
    return torch.softmax(x, dim=axis)
def _gelu(x):
    return torch.nn.functional.gelu(x, approximate="tanh")
def _silu(x):
    return torch.nn.functional.silu(x)
def _sigmoid(x):
    return torch.sigmoid(x)
def _layernorm(x, axis=-1, eps=1e-5):
    m = x.mean(dim=axis, keepdim=True)
    v = x.var(dim=axis, keepdim=True, unbiased=False)
    return (x - m) / torch.sqrt(v + eps)
def _scatter_add(tgt, idx, src, axis=0):
    return tgt.clone().index_add_(axis, idx, src)
def _segment_sum(src, seg, n):
    out = torch.zeros((n,) + src.shape[1:], dtype=src.dtype)
    return out.index_add_(0, seg, src)
def _pad(x, pw):
    flat = tuple(v for pair in reversed(pw) for v in pair)
    return torch.nn.functional.pad(x, flat)

kernel_name = 'parallel_sum__linear_attn_block__mixer_token_mlp__prompt'

def setup_inputs():

    _w = (lambda a: (lambda t: t.to(torch.bfloat16) if t.is_floating_point() else t)(torch.as_tensor(a)))
    def _A_setup():
        B, S, D = 1, 2048, 640
        return {
            "x": _w((lambda *s: torch.randn(*s, dtype=torch.bfloat16) * 0.05)(B, S, D)),
            "wqkv": _w((lambda *s: torch.randn(*s, dtype=torch.bfloat16) * 0.05)(D, 3 * D)),
            "wo": _w((lambda *s: torch.randn(*s, dtype=torch.bfloat16) * 0.05)(D, D)),
        }
    _A_in = _A_setup()

    def _B_setup():
        B, S, D, F = 1, 2048, 640, 1728
        return {
            "x": _w((lambda *s: torch.randn(*s, dtype=torch.bfloat16) * 0.05)(B, S, D)),
            "w1": _w((lambda *s: torch.randn(*s, dtype=torch.bfloat16) * 0.4)(S, F) * (S ** -0.5)),
            "b1": _w((lambda *s: torch.randn(*s, dtype=torch.bfloat16) * 3.2)(F) * 0.02),
            "w2": _w((lambda *s: torch.randn(*s, dtype=torch.bfloat16) * 0.2)(F, S) * (F ** -0.5)),
            "b2": _w((lambda *s: torch.randn(*s, dtype=torch.bfloat16) * 0.4)(S) * 0.02),
        }
    _B_in = _B_setup()

    return {
        "A_x": _A_in["x"],
        "A_wqkv": _A_in["wqkv"],
        "A_wo": _A_in["wo"],
        "B_x": _B_in["x"],
        "B_w1": _B_in["w1"],
        "B_b1": _B_in["b1"],
        "B_w2": _B_in["w2"],
        "B_b2": _B_in["b2"],
    }

def reference(A_x, A_wqkv, A_wo, B_x, B_w1, B_b1, B_w2, B_b2):
    def _A_ref(x, wqkv, wo):
        B, S, D = x.shape
        H = 32; Dh = D // H
        qkv = (lambda x, *d: x.permute(*d))((x @ wqkv).reshape(B, S, 3, H, Dh), 2, 0, 3, 1, 4)
        q, k, v = qkv[0], qkv[1], qkv[2]
        phi = lambda t: torch.where(t > 0, t + 1, torch.exp(t)) + 1e-6
        pq, pk = phi(q), phi(k)
        kv = torch.einsum("bhsd,bhse->bhde", pk, v)
        z = torch.einsum("bhsd->bhd", pk)
        num = torch.einsum("bhqd,bhde->bhqe", pq, kv)
        den = torch.einsum("bhqd,bhd->bhq", pq, z)[..., None] + 1e-6
        o = num / den
        return (lambda x, *d: x.permute(*d))(o, 0, 2, 1, 3).reshape(B, S, D) @ wo

    def _B_ref(x, w1, b1, w2, b2):
        B, S, D = x.shape
        h = _layernorm(x, axis=-1)
        u = torch.einsum("bsd,sf->bdf", h, w1) + b1
        u = _gelu(u)
        y = torch.einsum("bdf,fs->bds", u, w2) + b2
        return (lambda x, *d: x.permute(*d))(y, 0, 2, 1)

    x = A_x
    xn = _layernorm(x, axis=-1)
    return x + _A_ref(xn, A_wqkv, A_wo) + _B_ref(xn, B_w1, B_b1, B_w2, B_b2)
```

```asm
; @launch kernel=m_kernel grid=(256,1,1) block=(512,1,1) lds=163840
.amdgcn_target "amdgcn-amd-amdhsa--gfx950"
.text
.globl m_kernel
.p2align 8
.type m_kernel,@function
m_kernel:
s_cmp_ge_u32 s2, 256
s_cbranch_scc1 k_end
s_load_dwordx4 s[4:7], s[0:1], 0
s_load_dwordx2 s[12:13], s[0:1], 16
s_load_dwordx8 s[84:91], s[0:1], 32
s_load_dwordx4 s[92:95], s[0:1], 64
s_load_dwordx2 s[14:15], s[0:1], 80
v_and_b32 v1, 63, v0
v_lshrrev_b32 v2, 6, v0
s_and_b32 s40, s2, 7
s_lshr_b32 s41, s2, 3
v_readfirstlane_b32 s42, v2
s_lshr_b32 s46, s40, 1
s_lshl_b32 s43, s46, 2
s_and_b32 s45, s41, 3
s_add_u32 s43, s43, s45
s_and_b32 s44, s40, 1
s_lshl_b32 s97, s44, 2
s_add_u32 s97, s97, s45
s_lshr_b32 s45, s41, 2
s_sub_u32 s49, s42, 4
s_mov_b32 s98, 0
s_mov_b32 s61, 1
s_cmp_ge_u32 s41, 24
s_cbranch_scc1 r_aux
s_cmp_ge_u32 s41, 16
s_cbranch_scc1 r_q
s_lshl_b32 s44, s44, 2
s_add_u32 s44, s44, s45
s_mul_i32 s47, s44, 160
s_add_u32 s47, s47, 1280
s_mul_i32 s96, s46, 3
s_add_u32 s96, s96, s45
s_add_u32 s96, s96, 16
s_cmp_ge_u32 s96, 27
s_cselect_b32 s98, 2, 0
s_cmp_eq_u32 s45, 3
s_cselect_b32 s98, 1, s98
s_cmp_lt_u32 s42, 4
s_cbranch_scc1 ckv
lkv:
s_lshl_b32 s45, s43, 7
s_lshl_b32 s46, s49, 5
s_add_u32 s45, s45, s46
s_mul_i32 s51, s45, 1280
s_mov_b32 s52, s47
v_lshrrev_b32 v2, 3, v1
v_mul_u32_u24 v2, 1280, v2
v_lshrrev_b32 v3, 4, v1
v_and_b32 v4, 7, v1
v_xor_b32 v3, v3, v4
v_lshl_add_u32 v10, v3, 4, v2
s_lshl_b32 s60, s49, 12
s_mul_i32 s61, s49, 5120
s_add_u32 s61, s61, 16384
s_mul_i32 s46, s49, 320
s_mov_b32 s58, 0
s_mov_b32 s59, 0
s_mov_b32 s53, s60
s_mov_b32 s57, s61
s_waitcnt lgkmcnt(0)
s_mov_b32 s16, s4
s_mov_b32 s17, s5
s_mov_b32 s18, 2621440
s_mov_b32 s19, 0x00020000
s_add_u32 m0, s53, 0
s_nop 0
buffer_load_dwordx4 v10, s[16:19], s51 offen lds
v_xor_b32 v11, 64, v10
v_add_u32 v11, 10240, v11
s_add_u32 m0, s53, 1024
s_nop 0
buffer_load_dwordx4 v11, s[16:19], s51 offen lds
v_add_u32 v12, 20480, v10
s_add_u32 m0, s53, 2048
s_nop 0
buffer_load_dwordx4 v12, s[16:19], s51 offen lds
v_add_u32 v13, 20480, v11
s_add_u32 m0, s53, 3072
s_nop 0
buffer_load_dwordx4 v13, s[16:19], s51 offen lds
s_mov_b32 s20, s6
s_mov_b32 s21, s7
s_mov_b32 s22, 2457600
s_mov_b32 s23, 0x00020000
s_movk_i32 s62, 1280
s_movk_i32 s63, 1120
v_add_u32 v5, s46, v1
v_mul_u32_u24 v6, 6554, v5
v_lshlrev_b32 v7, 4, v5
v_lshrrev_b32 v8, 16, v6
v_lshrrev_b32 v6, 17, v6
v_mad_u32_u24 v7, v8, s63, v7
v_mad_u32_u24 v14, v6, s62, v7
s_add_u32 m0, s57, 0
s_nop 0
buffer_load_dwordx4 v14, s[20:23], s52 offen lds
v_add_u32 v5, 64, v5
v_mul_u32_u24 v6, 6554, v5
v_lshlrev_b32 v7, 4, v5
v_lshrrev_b32 v8, 16, v6
v_lshrrev_b32 v6, 17, v6
v_mad_u32_u24 v7, v8, s63, v7
v_mad_u32_u24 v15, v6, s62, v7
s_add_u32 m0, s57, 1024
s_nop 0
buffer_load_dwordx4 v15, s[20:23], s52 offen lds
v_add_u32 v5, 64, v5
v_mul_u32_u24 v6, 6554, v5
v_lshlrev_b32 v7, 4, v5
v_lshrrev_b32 v8, 16, v6
v_lshrrev_b32 v6, 17, v6
v_mad_u32_u24 v7, v8, s63, v7
v_mad_u32_u24 v16, v6, s62, v7
s_add_u32 m0, s57, 2048
s_nop 0
buffer_load_dwordx4 v16, s[20:23], s52 offen lds
v_add_u32 v5, 64, v5
v_mul_u32_u24 v6, 6554, v5
v_lshlrev_b32 v7, 4, v5
v_lshrrev_b32 v8, 16, v6
v_lshrrev_b32 v6, 17, v6
v_mad_u32_u24 v7, v8, s63, v7
v_mad_u32_u24 v17, v6, s62, v7
s_add_u32 m0, s57, 3072
s_nop 0
buffer_load_dwordx4 v17, s[20:23], s52 offen lds
v_add_u32 v5, 64, v5
v_mul_u32_u24 v6, 6554, v5
v_lshlrev_b32 v7, 4, v5
v_lshrrev_b32 v8, 16, v6
v_lshrrev_b32 v6, 17, v6
v_mad_u32_u24 v7, v8, s63, v7
v_mad_u32_u24 v18, v6, s62, v7
s_add_u32 m0, s57, 4096
s_nop 0
buffer_load_dwordx4 v18, s[20:23], s52 offen lds
s_add_u32 s58, s58, 1
s_add_u32 s51, s51, 128
s_add_u32 s52, s52, 245760
s_add_u32 s59, s59, 36864
s_cmp_ge_u32 s59, 110592
s_cselect_b32 s59, 0, s59
s_add_u32 s53, s59, s60
s_add_u32 s57, s59, s61
s_add_u32 m0, s53, 0
s_nop 0
buffer_load_dwordx4 v10, s[16:19], s51 offen lds
s_add_u32 m0, s53, 1024
s_nop 0
buffer_load_dwordx4 v11, s[16:19], s51 offen lds
s_add_u32 m0, s53, 2048
s_nop 0
buffer_load_dwordx4 v12, s[16:19], s51 offen lds
s_add_u32 m0, s53, 3072
s_nop 0
buffer_load_dwordx4 v13, s[16:19], s51 offen lds
s_add_u32 m0, s57, 0
s_nop 0
buffer_load_dwordx4 v14, s[20:23], s52 offen lds
s_add_u32 m0, s57, 1024
s_nop 0
buffer_load_dwordx4 v15, s[20:23], s52 offen lds
s_add_u32 m0, s57, 2048
s_nop 0
buffer_load_dwordx4 v16, s[20:23], s52 offen lds
s_add_u32 m0, s57, 3072
s_nop 0
buffer_load_dwordx4 v17, s[20:23], s52 offen lds
s_add_u32 m0, s57, 4096
s_nop 0
buffer_load_dwordx4 v18, s[20:23], s52 offen lds
s_add_u32 s58, s58, 1
s_add_u32 s51, s51, 128
s_add_u32 s52, s52, 245760
s_add_u32 s59, s59, 36864
s_cmp_ge_u32 s59, 110592
s_cselect_b32 s59, 0, s59
s_add_u32 s53, s59, s60
s_add_u32 s57, s59, s61
v_and_b32 v6, 255, v0
v_mul_u32_u24 v2, 4370, v6
v_lshrrev_b32 v2, 16, v2
v_mul_u32_u24 v3, 15, v2
v_sub_u32 v3, v6, v3
v_mul_u32_u24 v4, 52, v3
v_lshrrev_b32 v4, 8, v4
v_mul_u32_u24 v4, 640, v4
v_lshl_add_u32 v3, v3, 7, v4
s_mul_i32 s45, s41, 17
s_add_u32 s46, s45, 128
v_add_u32 v2, s46, v2
v_mul_u32_u24 v2, 3840, v2
v_add_u32 v2, v2, v3
s_and_b32 s46, s40, 1
s_mul_i32 s46, s46, 640
v_add_u32 v2, s46, v2
buffer_load_dword v250, v2, s[20:23], 0 offen
s_add_u32 s8, s14, 15728640
s_addc_u32 s9, s15, 0
s_mov_b32 s10, 65536
s_mov_b32 s11, 0x00020000
s_mov_b32 s24, s94
s_mov_b32 s25, s95
s_mov_b32 s26, 256
s_mov_b32 s27, 0x00020000
s_and_b32 s28, s40, 1
s_lshl_b32 s28, s28, 7
s_mul_i32 s29, s40, 256
s_lshr_b32 s30, s41, 2
s_mul_i32 s30, s30, 2048
s_add_u32 s30, s30, s29
s_add_u32 s30, s30, 10240
s_add_u32 s31, s30, 16384
s_add_u32 s32, s30, 32768
s_add_u32 s33, s29, 59392
s_waitcnt vmcnt(10)
s_barrier
lkv_ld:
s_add_u32 m0, s53, 0
s_nop 0
buffer_load_dwordx4 v10, s[16:19], s51 offen lds
s_add_u32 m0, s53, 1024
s_nop 0
buffer_load_dwordx4 v11, s[16:19], s51 offen lds
s_add_u32 m0, s53, 2048
s_nop 0
buffer_load_dwordx4 v12, s[16:19], s51 offen lds
s_add_u32 m0, s53, 3072
s_nop 0
buffer_load_dwordx4 v13, s[16:19], s51 offen lds
s_add_u32 m0, s57, 0
s_nop 0
buffer_load_dwordx4 v14, s[20:23], s52 offen lds
s_add_u32 m0, s57, 1024
s_nop 0
buffer_load_dwordx4 v15, s[20:23], s52 offen lds
s_add_u32 m0, s57, 2048
s_nop 0
buffer_load_dwordx4 v16, s[20:23], s52 offen lds
s_add_u32 m0, s57, 3072
s_nop 0
buffer_load_dwordx4 v17, s[20:23], s52 offen lds
s_add_u32 m0, s57, 4096
s_nop 0
buffer_load_dwordx4 v18, s[20:23], s52 offen lds
s_add_u32 s58, s58, 1
s_add_u32 s51, s51, 128
s_add_u32 s52, s52, 245760
s_add_u32 s59, s59, 36864
s_cmp_ge_u32 s59, 110592
s_cselect_b32 s59, 0, s59
s_add_u32 s53, s59, s60
s_add_u32 s57, s59, s61
s_waitcnt vmcnt(9)
s_barrier
s_cmp_lt_u32 s58, 8
s_cbranch_scc1 lkv_ld
s_cmp_lg_u32 s49, 0
s_cbranch_scc1 lkvi_pi
buffer_load_dword v34, off, s[24:27], s28 sc1
lkvi_pi:
s_add_u32 m0, s53, 0
s_nop 0
buffer_load_dwordx4 v10, s[16:19], s51 offen lds
s_add_u32 m0, s53, 1024
s_nop 0
buffer_load_dwordx4 v11, s[16:19], s51 offen lds
s_add_u32 m0, s53, 2048
s_nop 0
buffer_load_dwordx4 v12, s[16:19], s51 offen lds
s_add_u32 m0, s53, 3072
s_nop 0
buffer_load_dwordx4 v13, s[16:19], s51 offen lds
s_add_u32 m0, s57, 0
s_nop 0
buffer_load_dwordx4 v14, s[20:23], s52 offen lds
s_add_u32 m0, s57, 1024
s_nop 0
buffer_load_dwordx4 v15, s[20:23], s52 offen lds
s_add_u32 m0, s57, 2048
s_nop 0
buffer_load_dwordx4 v16, s[20:23], s52 offen lds
s_add_u32 m0, s57, 3072
s_nop 0
buffer_load_dwordx4 v17, s[20:23], s52 offen lds
s_add_u32 m0, s57, 4096
s_nop 0
buffer_load_dwordx4 v18, s[20:23], s52 offen lds
s_add_u32 s58, s58, 1
s_add_u32 s51, s51, 128
s_add_u32 s52, s52, 245760
s_add_u32 s59, s59, 36864
s_cmp_ge_u32 s59, 110592
s_cselect_b32 s59, 0, s59
s_add_u32 s53, s59, s60
s_add_u32 s57, s59, s61
s_waitcnt vmcnt(9)
s_cmp_lg_u32 s49, 0
s_cbranch_scc1 lkvi_ok
s_mov_b32 s63, 0x40000
lkvi_chk:
v_readfirstlane_b32 s55, v34
s_nop 1
s_cmp_ge_u32 s55, 1
s_cbranch_scc1 lkvi_ok
s_sub_u32 s63, s63, 1
s_cbranch_scc1 lkvi_ok
buffer_load_dword v34, off, s[24:27], s28 sc1
s_waitcnt vmcnt(0)
s_branch lkvi_chk
lkvi_ok:
s_barrier
s_cmp_lg_u32 s49, 0
s_cbranch_scc1 lkvh_pi
buffer_load_dword v34, off, s[8:11], s29 sc1
lkvh_pi:
s_add_u32 m0, s53, 0
s_nop 0
buffer_load_dwordx4 v10, s[16:19], s51 offen lds
s_add_u32 m0, s53, 1024
s_nop 0
buffer_load_dwordx4 v11, s[16:19], s51 offen lds
s_add_u32 m0, s53, 2048
s_nop 0
buffer_load_dwordx4 v12, s[16:19], s51 offen lds
s_add_u32 m0, s53, 3072
s_nop 0
buffer_load_dwordx4 v13, s[16:19], s51 offen lds
s_add_u32 m0, s57, 0
s_nop 0
buffer_load_dwordx4 v14, s[20:23], s52 offen lds
s_add_u32 m0, s57, 1024
s_nop 0
buffer_load_dwordx4 v15, s[20:23], s52 offen lds
s_add_u32 m0, s57, 2048
s_nop 0
buffer_load_dwordx4 v16, s[20:23], s52 offen lds
s_add_u32 m0, s57, 3072
s_nop 0
buffer_load_dwordx4 v17, s[20:23], s52 offen lds
s_add_u32 m0, s57, 4096
s_nop 0
buffer_load_dwordx4 v18, s[20:23], s52 offen lds
s_add_u32 s58, s58, 1
s_add_u32 s51, s51, 128
s_add_u32 s52, s52, 245760
s_add_u32 s59, s59, 36864
s_cmp_ge_u32 s59, 110592
s_cselect_b32 s59, 0, s59
s_add_u32 s53, s59, s60
s_add_u32 s57, s59, s61
s_waitcnt vmcnt(9)
s_mov_b32 s99, 1
s_cmp_lg_u32 s98, 0
s_cbranch_scc1 l_nob
s_branch l_be
lq:
s_lshl_b32 s45, s43, 7
s_lshl_b32 s46, s49, 5
s_add_u32 s45, s45, s46
s_mul_i32 s51, s45, 1280
s_mov_b32 s52, s47
v_lshrrev_b32 v2, 3, v1
v_mul_u32_u24 v2, 1280, v2
v_lshrrev_b32 v3, 4, v1
v_and_b32 v4, 7, v1
v_xor_b32 v3, v3, v4
v_lshl_add_u32 v10, v3, 4, v2
s_lshl_b32 s60, s49, 12
s_mul_i32 s61, s49, 5120
s_add_u32 s61, s61, 16384
s_mul_i32 s46, s49, 320
s_mov_b32 s58, 0
s_mov_b32 s59, 0
s_mov_b32 s53, s60
s_mov_b32 s57, s61
s_waitcnt lgkmcnt(0)
s_mov_b32 s16, s4
s_mov_b32 s17, s5
s_mov_b32 s18, 2621440
s_mov_b32 s19, 0x00020000
s_add_u32 m0, s53, 0
s_nop 0
buffer_load_dwordx4 v10, s[16:19], s51 offen lds
v_xor_b32 v11, 64, v10
v_add_u32 v11, 10240, v11
s_add_u32 m0, s53, 1024
s_nop 0
buffer_load_dwordx4 v11, s[16:19], s51 offen lds
v_add_u32 v12, 20480, v10
s_add_u32 m0, s53, 2048
s_nop 0
buffer_load_dwordx4 v12, s[16:19], s51 offen lds
v_add_u32 v13, 20480, v11
s_add_u32 m0, s53, 3072
s_nop 0
buffer_load_dwordx4 v13, s[16:19], s51 offen lds
s_mov_b32 s20, s6
s_mov_b32 s21, s7
s_mov_b32 s22, 2457600
s_mov_b32 s23, 0x00020000
s_movk_i32 s62, 3520
s_movk_i32 s63, 1120
v_add_u32 v5, s46, v1
v_mul_u32_u24 v6, 3277, v5
v_lshlrev_b32 v7, 4, v5
v_lshrrev_b32 v6, 16, v6
v_mad_u32_u24 v14, v6, s62, v7
s_add_u32 m0, s57, 0
s_nop 0
buffer_load_dwordx4 v14, s[20:23], s52 offen lds
v_add_u32 v5, 64, v5
v_mul_u32_u24 v6, 3277, v5
v_lshlrev_b32 v7, 4, v5
v_lshrrev_b32 v6, 16, v6
v_mad_u32_u24 v15, v6, s62, v7
s_add_u32 m0, s57, 1024
s_nop 0
buffer_load_dwordx4 v15, s[20:23], s52 offen lds
v_add_u32 v5, 64, v5
v_mul_u32_u24 v6, 3277, v5
v_lshlrev_b32 v7, 4, v5
v_lshrrev_b32 v6, 16, v6
v_mad_u32_u24 v16, v6, s62, v7
s_add_u32 m0, s57, 2048
s_nop 0
buffer_load_dwordx4 v16, s[20:23], s52 offen lds
v_add_u32 v5, 64, v5
v_mul_u32_u24 v6, 3277, v5
v_lshlrev_b32 v7, 4, v5
v_lshrrev_b32 v6, 16, v6
v_mad_u32_u24 v17, v6, s62, v7
s_add_u32 m0, s57, 3072
s_nop 0
buffer_load_dwordx4 v17, s[20:23], s52 offen lds
v_add_u32 v5, 64, v5
v_mul_u32_u24 v6, 3277, v5
v_lshlrev_b32 v7, 4, v5
v_lshrrev_b32 v6, 16, v6
v_mad_u32_u24 v18, v6, s62, v7
s_add_u32 m0, s57, 4096
s_nop 0
buffer_load_dwordx4 v18, s[20:23], s52 offen lds
s_add_u32 s58, s58, 1
s_add_u32 s51, s51, 128
s_add_u32 s52, s52, 245760
s_add_u32 s59, s59, 36864
s_cmp_ge_u32 s59, 110592
s_cselect_b32 s59, 0, s59
s_add_u32 s53, s59, s60
s_add_u32 s57, s59, s61
s_add_u32 m0, s53, 0
s_nop 0
buffer_load_dwordx4 v10, s[16:19], s51 offen lds
s_add_u32 m0, s53, 1024
s_nop 0
buffer_load_dwordx4 v11, s[16:19], s51 offen lds
s_add_u32 m0, s53, 2048
s_nop 0
buffer_load_dwordx4 v12, s[16:19], s51 offen lds
s_add_u32 m0, s53, 3072
s_nop 0
buffer_load_dwordx4 v13, s[16:19], s51 offen lds
s_add_u32 m0, s57, 0
s_nop 0
buffer_load_dwordx4 v14, s[20:23], s52 offen lds
s_add_u32 m0, s57, 1024
s_nop 0
buffer_load_dwordx4 v15, s[20:23], s52 offen lds
s_add_u32 m0, s57, 2048
s_nop 0
buffer_load_dwordx4 v16, s[20:23], s52 offen lds
s_add_u32 m0, s57, 3072
s_nop 0
buffer_load_dwordx4 v17, s[20:23], s52 offen lds
s_add_u32 m0, s57, 4096
s_nop 0
buffer_load_dwordx4 v18, s[20:23], s52 offen lds
s_add_u32 s58, s58, 1
s_add_u32 s51, s51, 128
s_add_u32 s52, s52, 245760
s_add_u32 s59, s59, 36864
s_cmp_ge_u32 s59, 110592
s_cselect_b32 s59, 0, s59
s_add_u32 s53, s59, s60
s_add_u32 s57, s59, s61
v_and_b32 v6, 255, v0
v_mul_u32_u24 v2, 4370, v6
v_lshrrev_b32 v2, 16, v2
v_mul_u32_u24 v3, 15, v2
v_sub_u32 v3, v6, v3
v_mul_u32_u24 v4, 52, v3
v_lshrrev_b32 v4, 8, v4
v_mul_u32_u24 v4, 640, v4
v_lshl_add_u32 v3, v3, 7, v4
s_mul_i32 s45, s41, 17
s_add_u32 s46, s45, 128
v_add_u32 v2, s46, v2
v_mul_u32_u24 v2, 3840, v2
v_add_u32 v2, v2, v3
s_and_b32 s46, s40, 1
s_mul_i32 s46, s46, 640
v_add_u32 v2, s46, v2
buffer_load_dword v250, v2, s[20:23], 0 offen
s_add_u32 s8, s14, 15728640
s_addc_u32 s9, s15, 0
s_mov_b32 s10, 65536
s_mov_b32 s11, 0x00020000
s_mov_b32 s24, s94
s_mov_b32 s25, s95
s_mov_b32 s26, 256
s_mov_b32 s27, 0x00020000
s_and_b32 s28, s40, 1
s_lshl_b32 s28, s28, 7
s_mul_i32 s29, s40, 256
s_lshr_b32 s30, s41, 2
s_mul_i32 s30, s30, 2048
s_add_u32 s30, s30, s29
s_add_u32 s30, s30, 10240
s_add_u32 s31, s30, 16384
s_add_u32 s32, s30, 32768
s_add_u32 s33, s29, 59392
s_waitcnt vmcnt(10)
s_barrier
lq_ld:
s_add_u32 m0, s53, 0
s_nop 0
buffer_load_dwordx4 v10, s[16:19], s51 offen lds
s_add_u32 m0, s53, 1024
s_nop 0
buffer_load_dwordx4 v11, s[16:19], s51 offen lds
s_add_u32 m0, s53, 2048
s_nop 0
buffer_load_dwordx4 v12, s[16:19], s51 offen lds
s_add_u32 m0, s53, 3072
s_nop 0
buffer_load_dwordx4 v13, s[16:19], s51 offen lds
s_add_u32 m0, s57, 0
s_nop 0
buffer_load_dwordx4 v14, s[20:23], s52 offen lds
s_add_u32 m0, s57, 1024
s_nop 0
buffer_load_dwordx4 v15, s[20:23], s52 offen lds
s_add_u32 m0, s57, 2048
s_nop 0
buffer_load_dwordx4 v16, s[20:23], s52 offen lds
s_add_u32 m0, s57, 3072
s_nop 0
buffer_load_dwordx4 v17, s[20:23], s52 offen lds
s_add_u32 m0, s57, 4096
s_nop 0
buffer_load_dwordx4 v18, s[20:23], s52 offen lds
s_add_u32 s58, s58, 1
s_add_u32 s51, s51, 128
s_add_u32 s52, s52, 245760
s_add_u32 s59, s59, 36864
s_cmp_ge_u32 s59, 110592
s_cselect_b32 s59, 0, s59
s_add_u32 s53, s59, s60
s_add_u32 s57, s59, s61
s_waitcnt vmcnt(9)
s_barrier
s_cmp_lt_u32 s58, 8
s_cbranch_scc1 lq_ld
s_cmp_lg_u32 s49, 0
s_cbranch_scc1 lqi_pi
buffer_load_dword v34, off, s[24:27], s28 sc1
lqi_pi:
s_add_u32 m0, s53, 0
s_nop 0
buffer_load_dwordx4 v10, s[16:19], s51 offen lds
s_add_u32 m0, s53, 1024
s_nop 0
buffer_load_dwordx4 v11, s[16:19], s51 offen lds
s_add_u32 m0, s53, 2048
s_nop 0
buffer_load_dwordx4 v12, s[16:19], s51 offen lds
s_add_u32 m0, s53, 3072
s_nop 0
buffer_load_dwordx4 v13, s[16:19], s51 offen lds
s_add_u32 m0, s57, 0
s_nop 0
buffer_load_dwordx4 v14, s[20:23], s52 offen lds
s_add_u32 m0, s57, 1024
s_nop 0
buffer_load_dwordx4 v15, s[20:23], s52 offen lds
s_add_u32 m0, s57, 2048
s_nop 0
buffer_load_dwordx4 v16, s[20:23], s52 offen lds
s_add_u32 m0, s57, 3072
s_nop 0
buffer_load_dwordx4 v17, s[20:23], s52 offen lds
s_add_u32 m0, s57, 4096
s_nop 0
buffer_load_dwordx4 v18, s[20:23], s52 offen lds
s_add_u32 s58, s58, 1
s_add_u32 s51, s51, 128
s_add_u32 s52, s52, 245760
s_add_u32 s59, s59, 36864
s_cmp_ge_u32 s59, 110592
s_cselect_b32 s59, 0, s59
s_add_u32 s53, s59, s60
s_add_u32 s57, s59, s61
s_waitcnt vmcnt(9)
s_cmp_lg_u32 s49, 0
s_cbranch_scc1 lqi_ok
s_mov_b32 s63, 0x40000
lqi_chk:
v_readfirstlane_b32 s55, v34
s_nop 1
s_cmp_ge_u32 s55, 1
s_cbranch_scc1 lqi_ok
s_sub_u32 s63, s63, 1
s_cbranch_scc1 lqi_ok
buffer_load_dword v34, off, s[24:27], s28 sc1
s_waitcnt vmcnt(0)
s_branch lqi_chk
lqi_ok:
s_barrier
s_cmp_lg_u32 s49, 0
s_cbranch_scc1 lqh_pi
buffer_load_dword v34, off, s[8:11], s29 sc1
lqh_pi:
s_add_u32 m0, s53, 0
s_nop 0
buffer_load_dwordx4 v10, s[16:19], s51 offen lds
s_add_u32 m0, s53, 1024
s_nop 0
buffer_load_dwordx4 v11, s[16:19], s51 offen lds
s_add_u32 m0, s53, 2048
s_nop 0
buffer_load_dwordx4 v12, s[16:19], s51 offen lds
s_add_u32 m0, s53, 3072
s_nop 0
buffer_load_dwordx4 v13, s[16:19], s51 offen lds
s_add_u32 m0, s57, 0
s_nop 0
buffer_load_dwordx4 v14, s[20:23], s52 offen lds
s_add_u32 m0, s57, 1024
s_nop 0
buffer_load_dwordx4 v15, s[20:23], s52 offen lds
s_add_u32 m0, s57, 2048
s_nop 0
buffer_load_dwordx4 v16, s[20:23], s52 offen lds
s_add_u32 m0, s57, 3072
s_nop 0
buffer_load_dwordx4 v17, s[20:23], s52 offen lds
s_add_u32 m0, s57, 4096
s_nop 0
buffer_load_dwordx4 v18, s[20:23], s52 offen lds
s_add_u32 s58, s58, 1
s_add_u32 s51, s51, 128
s_add_u32 s52, s52, 245760
s_add_u32 s59, s59, 36864
s_cmp_ge_u32 s59, 110592
s_cselect_b32 s59, 0, s59
s_add_u32 s53, s59, s60
s_add_u32 s57, s59, s61
s_waitcnt vmcnt(9)
s_mov_b32 s99, 0
l_be:
s_cmp_lg_u32 s49, 0
s_cbranch_scc1 l_be_ok
s_mov_b32 s63, 0x40000
l_be_chk:
v_readfirstlane_b32 s55, v34
s_nop 1
s_cmp_ge_u32 s55, 64
s_cbranch_scc1 l_be_ok
s_sub_u32 s63, s63, 1
s_cbranch_scc1 l_be_ok
buffer_load_dword v34, off, s[8:11], s29 sc1
s_waitcnt vmcnt(0)
s_branch l_be_chk
l_be_ok:
s_barrier
s_add_u32 s24, s14, 15204352
s_addc_u32 s25, s15, 0
s_mov_b32 s26, 16384
s_mov_b32 s27, 0x00020000
s_lshl_b32 s45, s49, 8
s_add_u32 m0, s45, 142336
s_lshl_b32 s46, s43, 10
s_add_u32 s45, s45, s46
v_lshlrev_b32 v9, 2, v1
buffer_load_dword v9, s[24:27], s45 offen sc1 lds
s_mov_b32 s16, s84
s_mov_b32 s17, s85
s_mov_b32 s18, 7077888
s_mov_b32 s19, 0x00020000
s_add_u32 s20, s14, 12582912
s_addc_u32 s21, s15, 0
s_mov_b32 s22, 2621440
s_mov_b32 s23, 0x00020000
s_lshl_b32 s47, s96, 7
s_mul_i32 s48, s97, 5120
s_and_b32 s45, s49, 1
s_lshr_b32 s56, s49, 1
s_mul_i32 s46, s45, 110592
s_add_u32 s47, s47, s46
s_mul_i32 s46, s45, 2560
s_add_u32 s48, s48, s46
s_mul_i32 s60, s56, 18432
s_mul_i32 s46, s45, 5120
s_add_u32 s61, s60, s46
s_add_u32 s61, s61, 8192
s_lshl_b32 s46, s45, 12
s_add_u32 s60, s60, s46
s_lshl_b32 s45, s45, 2
s_mul_i32 s51, s56, 221184
s_mul_i32 s52, s56, 81920
s_mov_b32 s58, 0
s_add_u32 s53, s59, s60
s_add_u32 s57, s59, s61
v_lshrrev_b32 v2, 3, v1
v_and_b32 v4, 7, v1
v_bfe_u32 v3, v1, 4, 1
v_lshlrev_b32 v3, 1, v3
v_mul_u32_u24 v5, 3456, v2
v_add_u32 v5, s47, v5
v_xor_b32 v6, v3, v4
v_lshl_add_u32 v10, v6, 4, v5
v_xor_b32 v6, 4, v6
v_lshl_add_u32 v11, v6, 4, v5
v_add_u32 v11, 27648, v11
v_add_u32 v12, 55296, v10
v_add_u32 v13, 55296, v11
v_lshrrev_b32 v3, 4, v1
v_xor_b32 v3, v3, v4
v_xor_b32 v3, s45, v3
v_mul_u32_u24 v7, 64, v2
v_add_u32 v7, s48, v7
v_lshl_add_u32 v14, v3, 4, v7
v_xor_b32 v3, 4, v3
v_lshl_add_u32 v15, v3, 4, v7
v_add_u32 v15, 512, v15
v_lshrrev_b32 v3, 2, v3
v_mul_u32_u24 v8, 40896, v3
v_add_u32 v15, v15, v8
v_xor_b32 v3, 1, v3
v_mul_u32_u24 v8, 40896, v3
v_add_u32 v14, v14, v8
v_add_u32 v16, 1024, v14
v_add_u32 v17, 1024, v15
v_add_u32 v18, 1024, v16
s_add_u32 m0, s53, 0
s_nop 0
buffer_load_dwordx4 v10, s[16:19], s51 offen lds
s_add_u32 m0, s57, 0
s_nop 0
buffer_load_dwordx4 v14, s[20:23], s52 offen sc1 lds
s_add_u32 m0, s53, 1024
s_nop 0
buffer_load_dwordx4 v11, s[16:19], s51 offen lds
s_add_u32 m0, s57, 1024
s_nop 0
buffer_load_dwordx4 v15, s[20:23], s52 offen sc1 lds
s_add_u32 m0, s53, 2048
s_nop 0
buffer_load_dwordx4 v12, s[16:19], s51 offen lds
s_add_u32 m0, s57, 2048
s_nop 0
buffer_load_dwordx4 v16, s[20:23], s52 offen sc1 lds
s_add_u32 m0, s53, 3072
s_nop 0
buffer_load_dwordx4 v13, s[16:19], s51 offen lds
s_add_u32 m0, s57, 3072
s_nop 0
buffer_load_dwordx4 v17, s[20:23], s52 offen sc1 lds
s_add_u32 m0, s57, 4096
s_nop 0
buffer_load_dwordx4 v18, s[20:23], s52 offen sc1 lds
s_add_u32 s58, s58, 1
s_add_u32 s51, s51, 442368
s_add_u32 s52, s52, 163840
s_add_u32 s56, s56, 2
s_add_u32 s59, s59, 36864
s_cmp_ge_u32 s59, 110592
s_cselect_b32 s59, 0, s59
s_add_u32 s53, s59, s60
s_add_u32 s57, s59, s61
s_waitcnt vmcnt(9)
s_barrier
s_add_u32 m0, s53, 0
s_nop 0
buffer_load_dwordx4 v10, s[16:19], s51 offen lds
s_add_u32 m0, s57, 0
s_nop 0
buffer_load_dwordx4 v14, s[20:23], s52 offen sc1 lds
s_add_u32 m0, s53, 1024
s_nop 0
buffer_load_dwordx4 v11, s[16:19], s51 offen lds
s_add_u32 m0, s57, 1024
s_nop 0
buffer_load_dwordx4 v15, s[20:23], s52 offen sc1 lds
s_add_u32 m0, s53, 2048
s_nop 0
buffer_load_dwordx4 v12, s[16:19], s51 offen lds
s_add_u32 m0, s57, 2048
s_nop 0
buffer_load_dwordx4 v16, s[20:23], s52 offen sc1 lds
s_add_u32 m0, s53, 3072
s_nop 0
buffer_load_dwordx4 v13, s[16:19], s51 offen lds
s_add_u32 m0, s57, 3072
s_nop 0
buffer_load_dwordx4 v17, s[20:23], s52 offen sc1 lds
s_add_u32 m0, s57, 4096
s_nop 0
buffer_load_dwordx4 v18, s[20:23], s52 offen sc1 lds
s_add_u32 s58, s58, 1
s_add_u32 s51, s51, 442368
s_add_u32 s52, s52, 163840
s_add_u32 s56, s56, 2
s_add_u32 s59, s59, 36864
s_cmp_ge_u32 s59, 110592
s_cselect_b32 s59, 0, s59
s_add_u32 s53, s59, s60
s_add_u32 s57, s59, s61
s_barrier
s_barrier
s_add_u32 m0, s53, 0
s_nop 0
buffer_load_dwordx4 v10, s[16:19], s51 offen lds
s_add_u32 m0, s57, 0
s_nop 0
buffer_load_dwordx4 v14, s[20:23], s52 offen sc1 lds
s_add_u32 m0, s53, 1024
s_nop 0
buffer_load_dwordx4 v11, s[16:19], s51 offen lds
s_add_u32 m0, s57, 1024
s_nop 0
buffer_load_dwordx4 v15, s[20:23], s52 offen sc1 lds
s_add_u32 m0, s53, 2048
s_nop 0
buffer_load_dwordx4 v12, s[16:19], s51 offen lds
s_add_u32 m0, s57, 2048
s_nop 0
buffer_load_dwordx4 v16, s[20:23], s52 offen sc1 lds
s_add_u32 m0, s53, 3072
s_nop 0
buffer_load_dwordx4 v13, s[16:19], s51 offen lds
s_add_u32 m0, s57, 3072
s_nop 0
buffer_load_dwordx4 v17, s[20:23], s52 offen sc1 lds
s_add_u32 m0, s57, 4096
s_nop 0
buffer_load_dwordx4 v18, s[20:23], s52 offen sc1 lds
s_add_u32 s58, s58, 1
s_add_u32 s51, s51, 442368
s_add_u32 s52, s52, 163840
s_add_u32 s56, s56, 2
s_add_u32 s59, s59, 36864
s_cmp_ge_u32 s59, 110592
s_cselect_b32 s59, 0, s59
s_add_u32 s53, s59, s60
s_add_u32 s57, s59, s61
s_cmp_eq_u32 s99, 0
s_cbranch_scc1 l_bq
s_mov_b32 s24, s84
s_mov_b32 s25, s85
s_mov_b32 s26, 7077888
s_mov_b32 s27, 0x00020000
s_and_b32 s45, s41, 3
s_mul_i32 s45, s45, 208
s_add_u32 s45, s45, 128
v_add_u32 v2, s45, v0
v_mul_u32_u24 v2, 3456, v2
s_lshl_b32 s45, s96, 7
v_mov_b32 v4, 1073741824
v_cmp_gt_u32 vcc, 464, v0
s_nop 1
v_cndmask_b32 v2, v4, v2, vcc
buffer_load_dword v240, v2, s[24:27], s45 offen
s_barrier
s_barrier
s_barrier
s_branch l_bj
l_bq:
s_barrier
s_barrier
s_mov_b32 s24, s84
s_mov_b32 s25, s85
s_mov_b32 s26, 7077888
s_mov_b32 s27, 0x00020000
s_and_b32 s45, s41, 3
s_mul_i32 s45, s45, 208
s_add_u32 s45, s45, 128
v_add_u32 v2, s45, v0
v_mul_u32_u24 v2, 3456, v2
s_lshl_b32 s45, s96, 7
v_mov_b32 v4, 1073741824
v_cmp_gt_u32 vcc, 464, v0
s_nop 1
v_cndmask_b32 v2, v4, v2, vcc
buffer_load_dword v240, v2, s[24:27], s45 offen
l_bj:
s_mov_b32 s24, s84
s_mov_b32 s25, s85
s_mov_b32 s26, 7077888
s_mov_b32 s27, 0x00020000
s_and_b32 s45, s41, 3
s_mul_i32 s45, s45, 208
s_add_u32 s45, s45, 960
v_add_u32 v2, s45, v0
v_mul_u32_u24 v2, 3456, v2
s_lshl_b32 s45, s96, 7
v_mov_b32 v4, 1073741824
v_cmp_gt_u32 vcc, 464, v0
s_nop 1
v_cndmask_b32 v2, v4, v2, vcc
buffer_load_dword v241, v2, s[24:27], s45 offen
s_waitcnt vmcnt(20)
s_barrier
s_waitcnt vmcnt(11)
s_barrier
s_add_u32 m0, s53, 0
s_nop 0
buffer_load_dwordx4 v10, s[16:19], s51 offen lds
s_add_u32 m0, s57, 0
s_nop 0
buffer_load_dwordx4 v14, s[20:23], s52 offen sc1 lds
s_add_u32 m0, s53, 1024
s_nop 0
buffer_load_dwordx4 v11, s[16:19], s51 offen lds
s_add_u32 m0, s57, 1024
s_nop 0
buffer_load_dwordx4 v15, s[20:23], s52 offen sc1 lds
s_add_u32 m0, s53, 2048
s_nop 0
buffer_load_dwordx4 v12, s[16:19], s51 offen lds
s_add_u32 m0, s57, 2048
s_nop 0
buffer_load_dwordx4 v16, s[20:23], s52 offen sc1 lds
s_add_u32 m0, s53, 3072
s_nop 0
buffer_load_dwordx4 v13, s[16:19], s51 offen lds
s_add_u32 m0, s57, 3072
s_nop 0
buffer_load_dwordx4 v17, s[20:23], s52 offen sc1 lds
s_add_u32 m0, s57, 4096
s_nop 0
buffer_load_dwordx4 v18, s[20:23], s52 offen sc1 lds
s_add_u32 s58, s58, 1
s_add_u32 s51, s51, 442368
s_add_u32 s52, s52, 163840
s_add_u32 s56, s56, 2
s_add_u32 s59, s59, 36864
s_cmp_ge_u32 s59, 110592
s_cselect_b32 s59, 0, s59
s_add_u32 s53, s59, s60
s_add_u32 s57, s59, s61
s_waitcnt vmcnt(11)
s_barrier
l_bl:
s_add_u32 m0, s53, 0
s_nop 0
buffer_load_dwordx4 v10, s[16:19], s51 offen lds
s_add_u32 m0, s57, 0
s_nop 0
buffer_load_dwordx4 v14, s[20:23], s52 offen sc1 lds
s_add_u32 m0, s53, 1024
s_nop 0
buffer_load_dwordx4 v11, s[16:19], s51 offen lds
s_add_u32 m0, s57, 1024
s_nop 0
buffer_load_dwordx4 v15, s[20:23], s52 offen sc1 lds
s_add_u32 m0, s53, 2048
s_nop 0
buffer_load_dwordx4 v12, s[16:19], s51 offen lds
s_add_u32 m0, s57, 2048
s_nop 0
buffer_load_dwordx4 v16, s[20:23], s52 offen sc1 lds
s_add_u32 m0, s53, 3072
s_nop 0
buffer_load_dwordx4 v13, s[16:19], s51 offen lds
s_add_u32 m0, s57, 3072
s_nop 0
buffer_load_dwordx4 v17, s[20:23], s52 offen sc1 lds
s_add_u32 m0, s57, 4096
s_nop 0
buffer_load_dwordx4 v18, s[20:23], s52 offen sc1 lds
s_add_u32 s58, s58, 1
s_add_u32 s51, s51, 442368
s_add_u32 s52, s52, 163840
s_add_u32 s56, s56, 2
s_add_u32 s59, s59, 36864
s_cmp_ge_u32 s59, 110592
s_cselect_b32 s59, 0, s59
s_add_u32 s53, s59, s60
s_add_u32 s57, s59, s61
s_waitcnt vmcnt(9)
s_barrier
s_cmp_lt_u32 s58, 15
s_cbranch_scc1 l_bl
s_add_u32 m0, s53, 0
s_nop 0
buffer_load_dwordx4 v10, s[16:19], s51 offen lds
s_add_u32 m0, s57, 0
s_nop 0
buffer_load_dwordx4 v14, s[20:23], s52 offen sc1 lds
s_add_u32 m0, s53, 1024
s_nop 0
buffer_load_dwordx4 v11, s[16:19], s51 offen lds
s_add_u32 m0, s57, 1024
s_nop 0
buffer_load_dwordx4 v15, s[20:23], s52 offen sc1 lds
s_add_u32 m0, s53, 2048
s_nop 0
buffer_load_dwordx4 v12, s[16:19], s51 offen lds
s_add_u32 m0, s57, 2048
s_nop 0
buffer_load_dwordx4 v16, s[20:23], s52 offen sc1 lds
s_add_u32 m0, s53, 3072
s_nop 0
buffer_load_dwordx4 v13, s[16:19], s51 offen lds
s_add_u32 m0, s57, 3072
s_nop 0
buffer_load_dwordx4 v17, s[20:23], s52 offen sc1 lds
s_add_u32 m0, s57, 4096
s_nop 0
buffer_load_dwordx4 v18, s[20:23], s52 offen sc1 lds
s_add_u32 s58, s58, 1
s_add_u32 s51, s51, 442368
s_add_u32 s52, s52, 163840
s_add_u32 s56, s56, 2
s_add_u32 s59, s59, 36864
s_cmp_ge_u32 s59, 110592
s_cselect_b32 s59, 0, s59
s_add_u32 s53, s59, s60
s_add_u32 s57, s59, s61
s_waitcnt vmcnt(9)
s_cmp_eq_u32 s98, 3
s_cbranch_scc1 l_bx
s_barrier
s_mov_b32 s16, s88
s_mov_b32 s17, s89
s_mov_b32 s18, 7077888
s_mov_b32 s19, 0x00020000
s_add_u32 s20, s14, 5242880
s_addc_u32 s21, s15, 0
s_mov_b32 s22, 3031040
s_mov_b32 s23, 0x00020000
s_add_u32 s36, s14, 8388608
s_addc_u32 s37, s15, 0
s_mov_b32 s38, 2621440
s_mov_b32 s39, 0x00020000
s_lshl_b32 s47, s40, 2
s_and_b32 s45, s41, 3
s_add_u32 s47, s47, s45
s_lshl_b32 s47, s47, 7
s_lshr_b32 s48, s41, 2
s_mul_i32 s48, s48, 378880
s_and_b32 s45, s49, 1
s_lshr_b32 s56, s49, 1
s_mul_i32 s46, s45, 131072
s_add_u32 s47, s47, s46
s_mul_i32 s46, s45, 189440
s_add_u32 s48, s48, s46
s_mul_i32 s60, s56, 18432
s_mul_i32 s46, s45, 5120
s_add_u32 s61, s60, s46
s_add_u32 s61, s61, 8192
s_lshl_b32 s46, s45, 12
s_add_u32 s60, s60, s46
s_lshl_b32 s45, s45, 2
s_mul_i32 s51, s56, 262144
s_mul_i32 s52, s56, 128
s_mov_b32 s58, 0
s_add_u32 s53, s59, s60
s_add_u32 s57, s59, s61
v_lshrrev_b32 v2, 3, v1
v_and_b32 v4, 7, v1
v_bfe_u32 v3, v1, 4, 1
v_lshlrev_b32 v3, 1, v3
v_mul_u32_u24 v5, 4096, v2
v_add_u32 v5, s47, v5
v_xor_b32 v6, v3, v4
v_lshl_add_u32 v10, v6, 4, v5
v_xor_b32 v6, 4, v6
v_lshl_add_u32 v11, v6, 4, v5
v_add_u32 v11, 32768, v11
v_add_u32 v12, 65536, v10
v_add_u32 v13, 65536, v11
v_lshrrev_b32 v3, 4, v1
v_xor_b32 v3, v3, v4
v_xor_b32 v3, s45, v3
v_mul_u32_u24 v7, 4736, v2
v_add_u32 v7, s48, v7
v_lshl_add_u32 v14, v3, 4, v7
v_xor_b32 v3, 4, v3
v_lshl_add_u32 v15, v3, 4, v7
v_add_u32 v15, 37888, v15
v_add_u32 v16, 75776, v14
v_add_u32 v17, 75776, v15
v_add_u32 v18, 75776, v16
s_waitcnt vmcnt(0)
s_barrier
s_cmp_lg_u32 s49, 0
s_cbranch_scc1 l_bp_pi
buffer_load_dword v34, off, s[8:11], s30 sc1
l_bp_pi:
s_barrier
s_waitcnt vmcnt(0)
v_mov_b32 v35, 163824
s_cmp_lg_u32 s49, 0
s_cbranch_scc1 l_h0
ds_write_b32 v35, v34
s_waitcnt lgkmcnt(0)
l_h0:
s_barrier
ds_read_b32 v34, v35
s_waitcnt lgkmcnt(0)
v_readfirstlane_b32 s55, v34
s_nop 1
s_cmp_lt_u32 s55, 8
s_cbranch_scc1 l_bx2
s_add_u32 m0, s53, 0
s_nop 0
buffer_load_dwordx4 v10, s[16:19], s51 offen sc1 lds
s_add_u32 m0, s57, 0
s_nop 0
buffer_load_dwordx4 v14, s[20:23], s52 offen sc1 lds
s_add_u32 m0, s53, 1024
s_nop 0
buffer_load_dwordx4 v11, s[16:19], s51 offen sc1 lds
s_add_u32 m0, s57, 1024
s_nop 0
buffer_load_dwordx4 v15, s[20:23], s52 offen sc1 lds
s_add_u32 m0, s53, 2048
s_nop 0
buffer_load_dwordx4 v12, s[16:19], s51 offen sc1 lds
s_add_u32 m0, s57, 2048
s_nop 0
buffer_load_dwordx4 v16, s[20:23], s52 offen sc1 lds
s_add_u32 m0, s53, 3072
s_nop 0
buffer_load_dwordx4 v13, s[16:19], s51 offen sc1 lds
s_add_u32 m0, s57, 3072
s_nop 0
buffer_load_dwordx4 v17, s[20:23], s52 offen sc1 lds
s_add_u32 m0, s57, 4096
s_nop 0
buffer_load_dwordx4 v18, s[20:23], s52 offen sc1 lds
s_add_u32 s58, s58, 1
s_add_u32 s51, s51, 524288
s_add_u32 s52, s52, 256
s_add_u32 s56, s56, 2
s_sub_u32 s45, s56, 27
s_mul_i32 s46, s45, 262144
s_cmp_lt_u32 s45, 2
s_cselect_b32 s16, s36, s16
s_cselect_b32 s17, s37, s17
s_cselect_b32 s18, s38, s18
s_cselect_b32 s51, s46, s51
s_cmp_ge_u32 s56, 37
s_cselect_b32 s52, 1073741824, s52
s_add_u32 s59, s59, 36864
s_cmp_ge_u32 s59, 110592
s_cselect_b32 s59, 0, s59
s_add_u32 s53, s59, s60
s_add_u32 s57, s59, s61
s_add_u32 m0, s53, 0
s_nop 0
buffer_load_dwordx4 v10, s[16:19], s51 offen sc1 lds
s_add_u32 m0, s57, 0
s_nop 0
buffer_load_dwordx4 v14, s[20:23], s52 offen sc1 lds
s_add_u32 m0, s53, 1024
s_nop 0
buffer_load_dwordx4 v11, s[16:19], s51 offen sc1 lds
s_add_u32 m0, s57, 1024
s_nop 0
buffer_load_dwordx4 v15, s[20:23], s52 offen sc1 lds
s_add_u32 m0, s53, 2048
s_nop 0
buffer_load_dwordx4 v12, s[16:19], s51 offen sc1 lds
s_add_u32 m0, s57, 2048
s_nop 0
buffer_load_dwordx4 v16, s[20:23], s52 offen sc1 lds
s_add_u32 m0, s53, 3072
s_nop 0
buffer_load_dwordx4 v13, s[16:19], s51 offen sc1 lds
s_add_u32 m0, s57, 3072
s_nop 0
buffer_load_dwordx4 v17, s[20:23], s52 offen sc1 lds
s_add_u32 m0, s57, 4096
s_nop 0
buffer_load_dwordx4 v18, s[20:23], s52 offen sc1 lds
s_add_u32 s58, s58, 1
s_add_u32 s51, s51, 524288
s_add_u32 s52, s52, 256
s_add_u32 s56, s56, 2
s_sub_u32 s45, s56, 27
s_mul_i32 s46, s45, 262144
s_cmp_lt_u32 s45, 2
s_cselect_b32 s16, s36, s16
s_cselect_b32 s17, s37, s17
s_cselect_b32 s18, s38, s18
s_cselect_b32 s51, s46, s51
s_cmp_ge_u32 s56, 37
s_cselect_b32 s52, 1073741824, s52
s_add_u32 s59, s59, 36864
s_cmp_ge_u32 s59, 110592
s_cselect_b32 s59, 0, s59
s_add_u32 s53, s59, s60
s_add_u32 s57, s59, s61
s_add_u32 m0, s53, 0
s_nop 0
buffer_load_dwordx4 v10, s[16:19], s51 offen sc1 lds
s_add_u32 m0, s57, 0
s_nop 0
buffer_load_dwordx4 v14, s[20:23], s52 offen sc1 lds
s_add_u32 m0, s53, 1024
s_nop 0
buffer_load_dwordx4 v11, s[16:19], s51 offen sc1 lds
s_add_u32 m0, s57, 1024
s_nop 0
buffer_load_dwordx4 v15, s[20:23], s52 offen sc1 lds
s_add_u32 m0, s53, 2048
s_nop 0
buffer_load_dwordx4 v12, s[16:19], s51 offen sc1 lds
s_add_u32 m0, s57, 2048
s_nop 0
buffer_load_dwordx4 v16, s[20:23], s52 offen sc1 lds
s_add_u32 m0, s53, 3072
s_nop 0
buffer_load_dwordx4 v13, s[16:19], s51 offen sc1 lds
s_add_u32 m0, s57, 3072
s_nop 0
buffer_load_dwordx4 v17, s[20:23], s52 offen sc1 lds
s_add_u32 m0, s57, 4096
s_nop 0
buffer_load_dwordx4 v18, s[20:23], s52 offen sc1 lds
s_add_u32 s58, s58, 1
s_add_u32 s51, s51, 524288
s_add_u32 s52, s52, 256
s_add_u32 s56, s56, 2
s_sub_u32 s45, s56, 27
s_mul_i32 s46, s45, 262144
s_cmp_lt_u32 s45, 2
s_cselect_b32 s16, s36, s16
s_cselect_b32 s17, s37, s17
s_cselect_b32 s18, s38, s18
s_cselect_b32 s51, s46, s51
s_cmp_ge_u32 s56, 37
s_cselect_b32 s52, 1073741824, s52
s_add_u32 s59, s59, 36864
s_cmp_ge_u32 s59, 110592
s_cselect_b32 s59, 0, s59
s_add_u32 s53, s59, s60
s_add_u32 s57, s59, s61
s_barrier
l_ce3:
s_barrier
s_barrier
s_waitcnt vmcnt(18)
s_barrier
s_waitcnt vmcnt(9)
s_barrier
l_c0:
s_mov_b32 s99, 0x0c0703
s_mov_b32 s34, 2108424
l_cl:
s_and_b32 s62, s99, 255
s_cmp_lg_u32 s58, s62
s_cbranch_scc1 l_c1
s_cmp_lg_u32 s49, 0
s_cbranch_scc1 l_cq_pi
buffer_load_dword v34, off, s[8:11], s31 sc1
l_cq_pi:
l_c1:
s_add_u32 m0, s53, 0
s_nop 0
buffer_load_dwordx4 v10, s[16:19], s51 offen sc1 lds
s_add_u32 m0, s57, 0
s_nop 0
buffer_load_dwordx4 v14, s[20:23], s52 offen sc1 lds
s_add_u32 m0, s53, 1024
s_nop 0
buffer_load_dwordx4 v11, s[16:19], s51 offen sc1 lds
s_add_u32 m0, s57, 1024
s_nop 0
buffer_load_dwordx4 v15, s[20:23], s52 offen sc1 lds
s_add_u32 m0, s53, 2048
s_nop 0
buffer_load_dwordx4 v12, s[16:19], s51 offen sc1 lds
s_add_u32 m0, s57, 2048
s_nop 0
buffer_load_dwordx4 v16, s[20:23], s52 offen sc1 lds
s_add_u32 m0, s53, 3072
s_nop 0
buffer_load_dwordx4 v13, s[16:19], s51 offen sc1 lds
s_add_u32 m0, s57, 3072
s_nop 0
buffer_load_dwordx4 v17, s[20:23], s52 offen sc1 lds
s_add_u32 m0, s57, 4096
s_nop 0
buffer_load_dwordx4 v18, s[20:23], s52 offen sc1 lds
s_add_u32 s58, s58, 1
s_add_u32 s51, s51, 524288
s_add_u32 s52, s52, 256
s_add_u32 s56, s56, 2
s_sub_u32 s45, s56, 27
s_mul_i32 s46, s45, 262144
s_cmp_lt_u32 s45, 2
s_cselect_b32 s16, s36, s16
s_cselect_b32 s17, s37, s17
s_cselect_b32 s18, s38, s18
s_cselect_b32 s51, s46, s51
s_cmp_ge_u32 s56, 37
s_cselect_b32 s52, 1073741824, s52
s_add_u32 s59, s59, 36864
s_cmp_ge_u32 s59, 110592
s_cselect_b32 s59, 0, s59
s_add_u32 s53, s59, s60
s_add_u32 s57, s59, s61
s_waitcnt vmcnt(9)
s_add_u32 s62, s62, 1
s_cmp_lg_u32 s58, s62
s_cbranch_scc1 l_c2
s_and_b32 s35, s34, 255
s_cmp_lg_u32 s49, 0
s_cbranch_scc1 l_cp_ok
s_mov_b32 s63, 0x40000
l_cp_chk:
v_readfirstlane_b32 s55, v34
s_nop 1
s_cmp_ge_u32 s55, s35
s_cbranch_scc1 l_cp_ok
s_sub_u32 s63, s63, 1
s_cbranch_scc1 l_cp_ok
buffer_load_dword v34, off, s[8:11], s31 sc1
s_waitcnt vmcnt(0)
s_branch l_cp_chk
l_cp_ok:
s_mov_b32 s31, s32
s_mov_b32 s32, s33
s_lshr_b32 s99, s99, 8
s_lshr_b32 s34, s34, 8
l_c2:
s_barrier
s_cmp_lt_u32 s58, 19
s_cbranch_scc1 l_cl
s_waitcnt vmcnt(0)
s_barrier
s_barrier
s_endpgm
l_nob:
s_cmp_lg_u32 s49, 0
s_cbranch_scc1 l_nb_ok
s_mov_b32 s63, 0x40000
l_nb_chk:
v_readfirstlane_b32 s55, v34
s_nop 1
s_cmp_ge_u32 s55, 64
s_cbranch_scc1 l_nb_ok
s_sub_u32 s63, s63, 1
s_cbranch_scc1 l_nb_ok
buffer_load_dword v34, off, s[8:11], s29 sc1
s_waitcnt vmcnt(0)
s_branch l_nb_chk
l_nb_ok:
s_barrier
s_add_u32 s24, s14, 15204352
s_addc_u32 s25, s15, 0
s_mov_b32 s26, 16384
s_mov_b32 s27, 0x00020000
s_lshl_b32 s45, s49, 8
s_add_u32 m0, s45, 142336
s_lshl_b32 s46, s43, 10
s_add_u32 s45, s45, s46
v_lshlrev_b32 v9, 2, v1
buffer_load_dword v9, s[24:27], s45 offen sc1 lds
s_waitcnt vmcnt(0)
s_barrier
s_barrier
s_barrier
s_mov_b32 s35, 0
s_mov_b32 s24, s88
s_mov_b32 s25, s89
s_mov_b32 s26, 7077888
s_mov_b32 s27, 0x00020000
s_sub_u32 s45, s35, 256
v_add_u32 v2, s45, v0
v_lshlrev_b32 v2, 12, v2
s_lshl_b32 s45, s40, 2
s_and_b32 s46, s41, 3
s_add_u32 s45, s45, s46
s_lshl_b32 s45, s45, 7
buffer_load_dword v242, v2, s[24:27], s45 offen
s_add_u32 s45, s45, 1048576
buffer_load_dword v243, v2, s[24:27], s45 offen
s_add_u32 s45, s45, 1048576
v_mov_b32 v4, 1073741824
v_cmp_gt_u32 vcc, 448, v0
s_nop 1
v_cndmask_b32 v2, v4, v2, vcc
buffer_load_dword v244, v2, s[24:27], s45 offen
s_add_u32 s45, s45, 1048576
s_barrier
s_cmp_lg_u32 s98, 1
s_cbranch_scc1 l_clate
v_mov_b32 v34, 0
v_mov_b32 v35, 163824
ds_write_b32 v35, v34
s_mov_b32 s59, 73728
s_mov_b32 s16, s88
s_mov_b32 s17, s89
s_mov_b32 s18, 7077888
s_mov_b32 s19, 0x00020000
s_add_u32 s20, s14, 5242880
s_addc_u32 s21, s15, 0
s_mov_b32 s22, 3031040
s_mov_b32 s23, 0x00020000
s_add_u32 s36, s14, 8388608
s_addc_u32 s37, s15, 0
s_mov_b32 s38, 2621440
s_mov_b32 s39, 0x00020000
s_lshl_b32 s47, s40, 2
s_and_b32 s45, s41, 3
s_add_u32 s47, s47, s45
s_lshl_b32 s47, s47, 7
s_lshr_b32 s48, s41, 2
s_mul_i32 s48, s48, 378880
s_and_b32 s45, s49, 1
s_lshr_b32 s56, s49, 1
s_mul_i32 s46, s45, 131072
s_add_u32 s47, s47, s46
s_mul_i32 s46, s45, 189440
s_add_u32 s48, s48, s46
s_mul_i32 s60, s56, 18432
s_mul_i32 s46, s45, 5120
s_add_u32 s61, s60, s46
s_add_u32 s61, s61, 8192
s_lshl_b32 s46, s45, 12
s_add_u32 s60, s60, s46
s_lshl_b32 s45, s45, 2
s_mul_i32 s51, s56, 262144
s_mul_i32 s52, s56, 128
s_mov_b32 s58, 0
s_add_u32 s53, s59, s60
s_add_u32 s57, s59, s61
v_lshrrev_b32 v2, 3, v1
v_and_b32 v4, 7, v1
v_bfe_u32 v3, v1, 4, 1
v_lshlrev_b32 v3, 1, v3
v_mul_u32_u24 v5, 4096, v2
v_add_u32 v5, s47, v5
v_xor_b32 v6, v3, v4
v_lshl_add_u32 v10, v6, 4, v5
v_xor_b32 v6, 4, v6
v_lshl_add_u32 v11, v6, 4, v5
v_add_u32 v11, 32768, v11
v_add_u32 v12, 65536, v10
v_add_u32 v13, 65536, v11
v_lshrrev_b32 v3, 4, v1
v_xor_b32 v3, v3, v4
v_xor_b32 v3, s45, v3
v_mul_u32_u24 v7, 4736, v2
v_add_u32 v7, s48, v7
v_lshl_add_u32 v14, v3, 4, v7
v_xor_b32 v3, 4, v3
v_lshl_add_u32 v15, v3, 4, v7
v_add_u32 v15, 37888, v15
v_add_u32 v16, 75776, v14
v_add_u32 v17, 75776, v15
v_add_u32 v18, 75776, v16
s_waitcnt lgkmcnt(0)
s_barrier
s_barrier
s_barrier
s_barrier
s_cmp_lg_u32 s49, 0
s_cbranch_scc1 l_op_ok
s_mov_b32 s63, 0x40000
l_op_chk:
v_readfirstlane_b32 s55, v34
s_nop 1
s_cmp_ge_u32 s55, 8
s_cbranch_scc1 l_op_ok
s_sub_u32 s63, s63, 1
s_cbranch_scc1 l_op_ok
buffer_load_dword v34, off, s[8:11], s30 sc1
s_waitcnt vmcnt(0)
s_branch l_op_chk
l_op_ok:
s_cmp_lg_u32 s49, 0
s_cbranch_scc1 l_ow
v_mov_b32 v34, 1
ds_write_b32 v35, v34
l_ow:
ds_read_b32 v34, v35
s_waitcnt lgkmcnt(0)
v_readfirstlane_b32 s55, v34
s_nop 1
s_cmp_eq_u32 s55, 0
s_cbranch_scc1 l_ow
s_add_u32 m0, s53, 0
s_nop 0
buffer_load_dwordx4 v10, s[16:19], s51 offen sc1 lds
s_add_u32 m0, s57, 0
s_nop 0
buffer_load_dwordx4 v14, s[20:23], s52 offen sc1 lds
s_add_u32 m0, s53, 1024
s_nop 0
buffer_load_dwordx4 v11, s[16:19], s51 offen sc1 lds
s_add_u32 m0, s57, 1024
s_nop 0
buffer_load_dwordx4 v15, s[20:23], s52 offen sc1 lds
s_add_u32 m0, s53, 2048
s_nop 0
buffer_load_dwordx4 v12, s[16:19], s51 offen sc1 lds
s_add_u32 m0, s57, 2048
s_nop 0
buffer_load_dwordx4 v16, s[20:23], s52 offen sc1 lds
s_add_u32 m0, s53, 3072
s_nop 0
buffer_load_dwordx4 v13, s[16:19], s51 offen sc1 lds
s_add_u32 m0, s57, 3072
s_nop 0
buffer_load_dwordx4 v17, s[20:23], s52 offen sc1 lds
s_add_u32 m0, s57, 4096
s_nop 0
buffer_load_dwordx4 v18, s[20:23], s52 offen sc1 lds
s_add_u32 s58, s58, 1
s_add_u32 s51, s51, 524288
s_add_u32 s52, s52, 256
s_add_u32 s56, s56, 2
s_sub_u32 s45, s56, 27
s_mul_i32 s46, s45, 262144
s_cmp_lt_u32 s45, 2
s_cselect_b32 s16, s36, s16
s_cselect_b32 s17, s37, s17
s_cselect_b32 s18, s38, s18
s_cselect_b32 s51, s46, s51
s_cmp_ge_u32 s56, 37
s_cselect_b32 s52, 1073741824, s52
s_add_u32 s59, s59, 36864
s_cmp_ge_u32 s59, 110592
s_cselect_b32 s59, 0, s59
s_add_u32 s53, s59, s60
s_add_u32 s57, s59, s61
s_add_u32 m0, s53, 0
s_nop 0
buffer_load_dwordx4 v10, s[16:19], s51 offen sc1 lds
s_add_u32 m0, s57, 0
s_nop 0
buffer_load_dwordx4 v14, s[20:23], s52 offen sc1 lds
s_add_u32 m0, s53, 1024
s_nop 0
buffer_load_dwordx4 v11, s[16:19], s51 offen sc1 lds
s_add_u32 m0, s57, 1024
s_nop 0
buffer_load_dwordx4 v15, s[20:23], s52 offen sc1 lds
s_add_u32 m0, s53, 2048
s_nop 0
buffer_load_dwordx4 v12, s[16:19], s51 offen sc1 lds
s_add_u32 m0, s57, 2048
s_nop 0
buffer_load_dwordx4 v16, s[20:23], s52 offen sc1 lds
s_add_u32 m0, s53, 3072
s_nop 0
buffer_load_dwordx4 v13, s[16:19], s51 offen sc1 lds
s_add_u32 m0, s57, 3072
s_nop 0
buffer_load_dwordx4 v17, s[20:23], s52 offen sc1 lds
s_add_u32 m0, s57, 4096
s_nop 0
buffer_load_dwordx4 v18, s[20:23], s52 offen sc1 lds
s_add_u32 s58, s58, 1
s_add_u32 s51, s51, 524288
s_add_u32 s52, s52, 256
s_add_u32 s56, s56, 2
s_sub_u32 s45, s56, 27
s_mul_i32 s46, s45, 262144
s_cmp_lt_u32 s45, 2
s_cselect_b32 s16, s36, s16
s_cselect_b32 s17, s37, s17
s_cselect_b32 s18, s38, s18
s_cselect_b32 s51, s46, s51
s_cmp_ge_u32 s56, 37
s_cselect_b32 s52, 1073741824, s52
s_add_u32 s59, s59, 36864
s_cmp_ge_u32 s59, 110592
s_cselect_b32 s59, 0, s59
s_add_u32 s53, s59, s60
s_add_u32 s57, s59, s61
s_add_u32 m0, s53, 0
s_nop 0
buffer_load_dwordx4 v10, s[16:19], s51 offen sc1 lds
s_add_u32 m0, s57, 0
s_nop 0
buffer_load_dwordx4 v14, s[20:23], s52 offen sc1 lds
s_add_u32 m0, s53, 1024
s_nop 0
buffer_load_dwordx4 v11, s[16:19], s51 offen sc1 lds
s_add_u32 m0, s57, 1024
s_nop 0
buffer_load_dwordx4 v15, s[20:23], s52 offen sc1 lds
s_add_u32 m0, s53, 2048
s_nop 0
buffer_load_dwordx4 v12, s[16:19], s51 offen sc1 lds
s_add_u32 m0, s57, 2048
s_nop 0
buffer_load_dwordx4 v16, s[20:23], s52 offen sc1 lds
s_add_u32 m0, s53, 3072
s_nop 0
buffer_load_dwordx4 v13, s[16:19], s51 offen sc1 lds
s_add_u32 m0, s57, 3072
s_nop 0
buffer_load_dwordx4 v17, s[20:23], s52 offen sc1 lds
s_add_u32 m0, s57, 4096
s_nop 0
buffer_load_dwordx4 v18, s[20:23], s52 offen sc1 lds
s_add_u32 s58, s58, 1
s_add_u32 s51, s51, 524288
s_add_u32 s52, s52, 256
s_add_u32 s56, s56, 2
s_sub_u32 s45, s56, 27
s_mul_i32 s46, s45, 262144
s_cmp_lt_u32 s45, 2
s_cselect_b32 s16, s36, s16
s_cselect_b32 s17, s37, s17
s_cselect_b32 s18, s38, s18
s_cselect_b32 s51, s46, s51
s_cmp_ge_u32 s56, 37
s_cselect_b32 s52, 1073741824, s52
s_add_u32 s59, s59, 36864
s_cmp_ge_u32 s59, 110592
s_cselect_b32 s59, 0, s59
s_add_u32 s53, s59, s60
s_add_u32 s57, s59, s61
s_branch l_ce3
l_bx:
s_barrier
s_waitcnt vmcnt(0)
s_barrier
s_barrier
s_barrier
l_bx2:
s_barrier
l_clate:
s_mov_b32 s59, 73728
s_mov_b32 s16, s88
s_mov_b32 s17, s89
s_mov_b32 s18, 7077888
s_mov_b32 s19, 0x00020000
s_add_u32 s20, s14, 5242880
s_addc_u32 s21, s15, 0
s_mov_b32 s22, 3031040
s_mov_b32 s23, 0x00020000
s_add_u32 s36, s14, 8388608
s_addc_u32 s37, s15, 0
s_mov_b32 s38, 2621440
s_mov_b32 s39, 0x00020000
s_lshl_b32 s47, s40, 2
s_and_b32 s45, s41, 3
s_add_u32 s47, s47, s45
s_lshl_b32 s47, s47, 7
s_lshr_b32 s48, s41, 2
s_mul_i32 s48, s48, 378880
s_and_b32 s45, s49, 1
s_lshr_b32 s56, s49, 1
s_mul_i32 s46, s45, 131072
s_add_u32 s47, s47, s46
s_mul_i32 s46, s45, 189440
s_add_u32 s48, s48, s46
s_mul_i32 s60, s56, 18432
s_mul_i32 s46, s45, 5120
s_add_u32 s61, s60, s46
s_add_u32 s61, s61, 8192
s_lshl_b32 s46, s45, 12
s_add_u32 s60, s60, s46
s_lshl_b32 s45, s45, 2
s_mul_i32 s51, s56, 262144
s_mul_i32 s52, s56, 128
s_mov_b32 s58, 0
s_add_u32 s53, s59, s60
s_add_u32 s57, s59, s61
v_lshrrev_b32 v2, 3, v1
v_and_b32 v4, 7, v1
v_bfe_u32 v3, v1, 4, 1
v_lshlrev_b32 v3, 1, v3
v_mul_u32_u24 v5, 4096, v2
v_add_u32 v5, s47, v5
v_xor_b32 v6, v3, v4
v_lshl_add_u32 v10, v6, 4, v5
v_xor_b32 v6, 4, v6
v_lshl_add_u32 v11, v6, 4, v5
v_add_u32 v11, 32768, v11
v_add_u32 v12, 65536, v10
v_add_u32 v13, 65536, v11
v_lshrrev_b32 v3, 4, v1
v_xor_b32 v3, v3, v4
v_xor_b32 v3, s45, v3
v_mul_u32_u24 v7, 4736, v2
v_add_u32 v7, s48, v7
v_lshl_add_u32 v14, v3, 4, v7
v_xor_b32 v3, 4, v3
v_lshl_add_u32 v15, v3, 4, v7
v_add_u32 v15, 37888, v15
v_add_u32 v16, 75776, v14
v_add_u32 v17, 75776, v15
v_add_u32 v18, 75776, v16
v_mov_b32 v34, 0
s_barrier
s_cmp_lg_u32 s98, 3
s_cbranch_scc1 l_np2
s_barrier
s_cmp_ge_u32 s41, 28
s_cselect_b32 s35, 512, 0
s_add_u32 s35, s35, 704
s_mov_b32 s24, s88
s_mov_b32 s25, s89
s_mov_b32 s26, 7077888
s_mov_b32 s27, 0x00020000
s_sub_u32 s45, s35, 256
v_add_u32 v2, s45, v0
v_lshlrev_b32 v2, 12, v2
s_lshl_b32 s45, s40, 2
s_and_b32 s46, s41, 3
s_add_u32 s45, s45, s46
s_lshl_b32 s45, s45, 7
buffer_load_dword v242, v2, s[24:27], s45 offen
s_add_u32 s45, s45, 1048576
buffer_load_dword v243, v2, s[24:27], s45 offen
s_add_u32 s45, s45, 1048576
l_np2:
s_cmp_lg_u32 s49, 0
s_cbranch_scc1 l_cx_ok
s_mov_b32 s63, 0x40000
l_cx_chk:
v_readfirstlane_b32 s55, v34
s_nop 1
s_cmp_ge_u32 s55, 8
s_cbranch_scc1 l_cx_ok
s_sub_u32 s63, s63, 1
s_cbranch_scc1 l_cx_ok
buffer_load_dword v34, off, s[8:11], s30 sc1
s_waitcnt vmcnt(0)
s_branch l_cx_chk
l_cx_ok:
s_barrier
s_add_u32 m0, s53, 0
s_nop 0
buffer_load_dwordx4 v10, s[16:19], s51 offen sc1 lds
s_add_u32 m0, s57, 0
s_nop 0
buffer_load_dwordx4 v14, s[20:23], s52 offen sc1 lds
s_add_u32 m0, s53, 1024
s_nop 0
buffer_load_dwordx4 v11, s[16:19], s51 offen sc1 lds
s_add_u32 m0, s57, 1024
s_nop 0
buffer_load_dwordx4 v15, s[20:23], s52 offen sc1 lds
s_add_u32 m0, s53, 2048
s_nop 0
buffer_load_dwordx4 v12, s[16:19], s51 offen sc1 lds
s_add_u32 m0, s57, 2048
s_nop 0
buffer_load_dwordx4 v16, s[20:23], s52 offen sc1 lds
s_add_u32 m0, s53, 3072
s_nop 0
buffer_load_dwordx4 v13, s[16:19], s51 offen sc1 lds
s_add_u32 m0, s57, 3072
s_nop 0
buffer_load_dwordx4 v17, s[20:23], s52 offen sc1 lds
s_add_u32 m0, s57, 4096
s_nop 0
buffer_load_dwordx4 v18, s[20:23], s52 offen sc1 lds
s_add_u32 s58, s58, 1
s_add_u32 s51, s51, 524288
s_add_u32 s52, s52, 256
s_add_u32 s56, s56, 2
s_sub_u32 s45, s56, 27
s_mul_i32 s46, s45, 262144
s_cmp_lt_u32 s45, 2
s_cselect_b32 s16, s36, s16
s_cselect_b32 s17, s37, s17
s_cselect_b32 s18, s38, s18
s_cselect_b32 s51, s46, s51
s_cmp_ge_u32 s56, 37
s_cselect_b32 s52, 1073741824, s52
s_add_u32 s59, s59, 36864
s_cmp_ge_u32 s59, 110592
s_cselect_b32 s59, 0, s59
s_add_u32 s53, s59, s60
s_add_u32 s57, s59, s61
s_add_u32 m0, s53, 0
s_nop 0
buffer_load_dwordx4 v10, s[16:19], s51 offen sc1 lds
s_add_u32 m0, s57, 0
s_nop 0
buffer_load_dwordx4 v14, s[20:23], s52 offen sc1 lds
s_add_u32 m0, s53, 1024
s_nop 0
buffer_load_dwordx4 v11, s[16:19], s51 offen sc1 lds
s_add_u32 m0, s57, 1024
s_nop 0
buffer_load_dwordx4 v15, s[20:23], s52 offen sc1 lds
s_add_u32 m0, s53, 2048
s_nop 0
buffer_load_dwordx4 v12, s[16:19], s51 offen sc1 lds
s_add_u32 m0, s57, 2048
s_nop 0
buffer_load_dwordx4 v16, s[20:23], s52 offen sc1 lds
s_add_u32 m0, s53, 3072
s_nop 0
buffer_load_dwordx4 v13, s[16:19], s51 offen sc1 lds
s_add_u32 m0, s57, 3072
s_nop 0
buffer_load_dwordx4 v17, s[20:23], s52 offen sc1 lds
s_add_u32 m0, s57, 4096
s_nop 0
buffer_load_dwordx4 v18, s[20:23], s52 offen sc1 lds
s_add_u32 s58, s58, 1
s_add_u32 s51, s51, 524288
s_add_u32 s52, s52, 256
s_add_u32 s56, s56, 2
s_sub_u32 s45, s56, 27
s_mul_i32 s46, s45, 262144
s_cmp_lt_u32 s45, 2
s_cselect_b32 s16, s36, s16
s_cselect_b32 s17, s37, s17
s_cselect_b32 s18, s38, s18
s_cselect_b32 s51, s46, s51
s_cmp_ge_u32 s56, 37
s_cselect_b32 s52, 1073741824, s52
s_add_u32 s59, s59, 36864
s_cmp_ge_u32 s59, 110592
s_cselect_b32 s59, 0, s59
s_add_u32 s53, s59, s60
s_add_u32 s57, s59, s61
s_waitcnt vmcnt(9)
s_barrier
s_branch l_c0
laux:
s_add_u32 s8, s14, 15728640
s_addc_u32 s9, s15, 0
s_mov_b32 s10, 65536
s_mov_b32 s11, 0x00020000
s_mov_b32 s24, s94
s_mov_b32 s25, s95
s_mov_b32 s26, 256
s_mov_b32 s27, 0x00020000
s_and_b32 s28, s40, 1
s_lshl_b32 s28, s28, 7
s_mul_i32 s29, s40, 256
s_lshr_b32 s30, s41, 2
s_mul_i32 s30, s30, 2048
s_add_u32 s30, s30, s29
s_add_u32 s30, s30, 10240
s_add_u32 s31, s30, 16384
s_add_u32 s32, s30, 32768
s_add_u32 s33, s29, 59392
v_mov_b32 v34, 0
s_cmp_lg_u32 s49, 0
s_cbranch_scc1 l_ai_ok
s_mov_b32 s63, 0x40000
l_ai_chk:
v_readfirstlane_b32 s55, v34
s_nop 1
s_cmp_ge_u32 s55, 1
s_cbranch_scc1 l_ai_ok
s_sub_u32 s63, s63, 1
s_cbranch_scc1 l_ai_ok
buffer_load_dword v34, off, s[24:27], s28 sc1
s_waitcnt vmcnt(0)
s_branch l_ai_chk
l_ai_ok:
s_waitcnt vmcnt(0)
s_barrier
s_barrier
s_mov_b32 s20, s6
s_mov_b32 s21, s7
s_mov_b32 s22, 2457600
s_mov_b32 s23, 0x00020000
v_and_b32 v6, 255, v0
v_mul_u32_u24 v2, 4370, v6
v_lshrrev_b32 v2, 16, v2
v_mul_u32_u24 v3, 15, v2
v_sub_u32 v3, v6, v3
v_mul_u32_u24 v4, 52, v3
v_lshrrev_b32 v4, 8, v4
v_mul_u32_u24 v4, 640, v4
v_lshl_add_u32 v3, v3, 7, v4
s_mul_i32 s45, s41, 17
s_add_u32 s46, s45, 128
v_add_u32 v2, s46, v2
v_mul_u32_u24 v2, 3840, v2
v_add_u32 v2, v2, v3
s_and_b32 s46, s40, 1
s_mul_i32 s46, s46, 640
v_add_u32 v2, s46, v2
buffer_load_dword v250, v2, s[20:23], 0 offen
s_mov_b32 s59, 36864
s_mov_b32 s16, s84
s_mov_b32 s17, s85
s_mov_b32 s18, 7077888
s_mov_b32 s19, 0x00020000
s_add_u32 s20, s14, 12582912
s_addc_u32 s21, s15, 0
s_mov_b32 s22, 2621440
s_mov_b32 s23, 0x00020000
s_lshl_b32 s47, s96, 7
s_mul_i32 s48, s97, 5120
s_and_b32 s45, s49, 1
s_lshr_b32 s56, s49, 1
s_mul_i32 s46, s45, 110592
s_add_u32 s47, s47, s46
s_mul_i32 s46, s45, 2560
s_add_u32 s48, s48, s46
s_mul_i32 s60, s56, 18432
s_mul_i32 s46, s45, 5120
s_add_u32 s61, s60, s46
s_add_u32 s61, s61, 8192
s_lshl_b32 s46, s45, 12
s_add_u32 s60, s60, s46
s_lshl_b32 s45, s45, 2
s_mul_i32 s51, s56, 221184
s_mul_i32 s52, s56, 81920
s_mov_b32 s58, 0
s_add_u32 s53, s59, s60
s_add_u32 s57, s59, s61
v_lshrrev_b32 v2, 3, v1
v_and_b32 v4, 7, v1
v_bfe_u32 v3, v1, 4, 1
v_lshlrev_b32 v3, 1, v3
v_mul_u32_u24 v5, 3456, v2
v_add_u32 v5, s47, v5
v_xor_b32 v6, v3, v4
v_lshl_add_u32 v10, v6, 4, v5
v_xor_b32 v6, 4, v6
v_lshl_add_u32 v11, v6, 4, v5
v_add_u32 v11, 27648, v11
v_add_u32 v12, 55296, v10
v_add_u32 v13, 55296, v11
v_lshrrev_b32 v3, 4, v1
v_xor_b32 v3, v3, v4
v_xor_b32 v3, s45, v3
v_mul_u32_u24 v7, 64, v2
v_add_u32 v7, s48, v7
v_lshl_add_u32 v14, v3, 4, v7
v_xor_b32 v3, 4, v3
v_lshl_add_u32 v15, v3, 4, v7
v_add_u32 v15, 512, v15
v_lshrrev_b32 v3, 2, v3
v_mul_u32_u24 v8, 40896, v3
v_add_u32 v15, v15, v8
v_xor_b32 v3, 1, v3
v_mul_u32_u24 v8, 40896, v3
v_add_u32 v14, v14, v8
v_add_u32 v16, 1024, v14
v_add_u32 v17, 1024, v15
v_add_u32 v18, 1024, v16
s_mov_b32 s24, s84
s_mov_b32 s25, s85
s_mov_b32 s26, 7077888
s_mov_b32 s27, 0x00020000
s_and_b32 s45, s41, 3
s_mul_i32 s45, s45, 256
s_add_u32 s45, s45, 768
v_add_u32 v2, s45, v0
v_mul_u32_u24 v2, 3456, v2
s_lshl_b32 s45, s96, 7
v_mov_b32 v4, 1073741824
v_cmp_gt_u32 vcc, 512, v0
s_nop 1
v_cndmask_b32 v2, v4, v2, vcc
buffer_load_dword v240, v2, s[24:27], s45 offen
v_mov_b32 v34, 0
s_cmp_lg_u32 s49, 0
s_cbranch_scc1 l_ax_ok
s_mov_b32 s63, 0x40000
l_ax_chk:
v_readfirstlane_b32 s55, v34
s_nop 1
s_cmp_ge_u32 s55, 64
s_cbranch_scc1 l_ax_ok
s_sub_u32 s63, s63, 1
s_cbranch_scc1 l_ax_ok
buffer_load_dword v34, off, s[8:11], s29 sc1
s_waitcnt vmcnt(0)
s_branch l_ax_chk
l_ax_ok:
s_barrier
s_add_u32 m0, s53, 0
s_nop 0
buffer_load_dwordx4 v10, s[16:19], s51 offen lds
s_add_u32 m0, s57, 0
s_nop 0
buffer_load_dwordx4 v14, s[20:23], s52 offen sc1 lds
s_add_u32 m0, s53, 1024
s_nop 0
buffer_load_dwordx4 v11, s[16:19], s51 offen lds
s_add_u32 m0, s57, 1024
s_nop 0
buffer_load_dwordx4 v15, s[20:23], s52 offen sc1 lds
s_add_u32 m0, s53, 2048
s_nop 0
buffer_load_dwordx4 v12, s[16:19], s51 offen lds
s_add_u32 m0, s57, 2048
s_nop 0
buffer_load_dwordx4 v16, s[20:23], s52 offen sc1 lds
s_add_u32 m0, s53, 3072
s_nop 0
buffer_load_dwordx4 v13, s[16:19], s51 offen lds
s_add_u32 m0, s57, 3072
s_nop 0
buffer_load_dwordx4 v17, s[20:23], s52 offen sc1 lds
s_add_u32 m0, s57, 4096
s_nop 0
buffer_load_dwordx4 v18, s[20:23], s52 offen sc1 lds
s_add_u32 s58, s58, 1
s_add_u32 s51, s51, 442368
s_add_u32 s52, s52, 163840
s_add_u32 s56, s56, 2
s_add_u32 s59, s59, 36864
s_cmp_ge_u32 s59, 147456
s_cselect_b32 s59, 0, s59
s_add_u32 s53, s59, s60
s_add_u32 s57, s59, s61
s_add_u32 m0, s53, 0
s_nop 0
buffer_load_dwordx4 v10, s[16:19], s51 offen lds
s_add_u32 m0, s57, 0
s_nop 0
buffer_load_dwordx4 v14, s[20:23], s52 offen sc1 lds
s_add_u32 m0, s53, 1024
s_nop 0
buffer_load_dwordx4 v11, s[16:19], s51 offen lds
s_add_u32 m0, s57, 1024
s_nop 0
buffer_load_dwordx4 v15, s[20:23], s52 offen sc1 lds
s_add_u32 m0, s53, 2048
s_nop 0
buffer_load_dwordx4 v12, s[16:19], s51 offen lds
s_add_u32 m0, s57, 2048
s_nop 0
buffer_load_dwordx4 v16, s[20:23], s52 offen sc1 lds
s_add_u32 m0, s53, 3072
s_nop 0
buffer_load_dwordx4 v13, s[16:19], s51 offen lds
s_add_u32 m0, s57, 3072
s_nop 0
buffer_load_dwordx4 v17, s[20:23], s52 offen sc1 lds
s_add_u32 m0, s57, 4096
s_nop 0
buffer_load_dwordx4 v18, s[20:23], s52 offen sc1 lds
s_add_u32 s58, s58, 1
s_add_u32 s51, s51, 442368
s_add_u32 s52, s52, 163840
s_add_u32 s56, s56, 2
s_add_u32 s59, s59, 36864
s_cmp_ge_u32 s59, 147456
s_cselect_b32 s59, 0, s59
s_add_u32 s53, s59, s60
s_add_u32 s57, s59, s61
l_b4:
s_add_u32 m0, s53, 0
s_nop 0
buffer_load_dwordx4 v10, s[16:19], s51 offen lds
s_add_u32 m0, s57, 0
s_nop 0
buffer_load_dwordx4 v14, s[20:23], s52 offen sc1 lds
s_add_u32 m0, s53, 1024
s_nop 0
buffer_load_dwordx4 v11, s[16:19], s51 offen lds
s_add_u32 m0, s57, 1024
s_nop 0
buffer_load_dwordx4 v15, s[20:23], s52 offen sc1 lds
s_add_u32 m0, s53, 2048
s_nop 0
buffer_load_dwordx4 v12, s[16:19], s51 offen lds
s_add_u32 m0, s57, 2048
s_nop 0
buffer_load_dwordx4 v16, s[20:23], s52 offen sc1 lds
s_add_u32 m0, s53, 3072
s_nop 0
buffer_load_dwordx4 v13, s[16:19], s51 offen lds
s_add_u32 m0, s57, 3072
s_nop 0
buffer_load_dwordx4 v17, s[20:23], s52 offen sc1 lds
s_add_u32 m0, s57, 4096
s_nop 0
buffer_load_dwordx4 v18, s[20:23], s52 offen sc1 lds
s_add_u32 s58, s58, 1
s_add_u32 s51, s51, 442368
s_add_u32 s52, s52, 163840
s_add_u32 s56, s56, 2
s_add_u32 s59, s59, 36864
s_cmp_ge_u32 s59, 147456
s_cselect_b32 s59, 0, s59
s_add_u32 s53, s59, s60
s_add_u32 s57, s59, s61
s_waitcnt vmcnt(18)
s_barrier
s_cmp_lt_u32 s58, 16
s_cbranch_scc1 l_b4
s_waitcnt vmcnt(9)
s_branch l_bx
r_q:
s_lshl_b32 s96, s46, 1
s_add_u32 s96, s96, s45
s_add_u32 s96, s96, 4
s_lshl_b32 s44, s44, 1
s_add_u32 s44, s44, s45
s_sub_u32 s44, s44, 4
s_mul_i32 s47, s44, 320
s_cmp_ge_u32 s42, 4
s_cbranch_scc1 lq
s_mul_i32 s56, s44, 2048
s_add_u32 s56, s56, 2048
s_mov_b32 s57, 255
s_mov_b32 s58, 26624
s_movk_i32 s61, 0x100
s_lshl_b32 s60, s42, 12
v_and_b32 v2, 31, v1
v_lshrrev_b32 v3, 5, v1
v_lshrrev_b32 v4, 1, v2
v_and_b32 v4, 7, v4
v_lshlrev_b32 v5, 7, v2
v_add_u32 v5, s60, v5
v_bfe_u32 v6, v1, 2, 2
v_lshl_add_u32 v6, v3, 3, v6
v_mul_u32_u24 v6, 320, v6
v_bfe_u32 v7, v1, 4, 1
v_lshlrev_b32 v7, 5, v7
v_and_b32 v8, 3, v1
v_lshl_add_u32 v7, v8, 3, v7
v_add_u32 v6, v6, v7
v_add_u32 v6, 16384, v6
s_add_u32 s45, s42, 0
s_and_b32 s45, s45, 3
s_lshl_b32 s46, s45, 1
s_mul_i32 s45, s45, 5120
v_add_u32 v7, s46, v3
v_xor_b32 v7, v7, v4
v_lshl_add_u32 v20, v7, 4, v5
v_add_u32 v24, s45, v6
v_mov_b32 v28, v20
v_mov_b32 v32, v24
s_add_u32 s45, s42, 1
s_and_b32 s45, s45, 3
s_lshl_b32 s46, s45, 1
s_mul_i32 s45, s45, 5120
v_add_u32 v7, s46, v3
v_xor_b32 v7, v7, v4
v_lshl_add_u32 v21, v7, 4, v5
v_add_u32 v25, s45, v6
v_mov_b32 v29, v21
v_mov_b32 v33, v25
s_add_u32 s45, s42, 2
s_and_b32 s45, s45, 3
s_lshl_b32 s46, s45, 1
s_mul_i32 s45, s45, 5120
v_add_u32 v7, s46, v3
v_xor_b32 v7, v7, v4
v_lshl_add_u32 v22, v7, 4, v5
v_add_u32 v26, s45, v6
v_mov_b32 v30, v22
v_mov_b32 v34, v26
s_add_u32 s45, s42, 3
s_and_b32 s45, s45, 3
s_lshl_b32 s46, s45, 1
s_mul_i32 s45, s45, 5120
v_add_u32 v7, s46, v3
v_xor_b32 v7, v7, v4
v_lshl_add_u32 v23, v7, 4, v5
v_add_u32 v27, s45, v6
v_mov_b32 v31, v23
v_mov_b32 v35, v27
s_mov_b32 s55, 0x3f803f80
s_mov_b32 s50, 0
s_mov_b32 s54, 0
v_mov_b32 v96, 0
v_mov_b32 v97, 0
v_mov_b32 v98, 0
v_mov_b32 v99, 0
v_mov_b32 v100, 0
v_mov_b32 v101, 0
v_mov_b32 v102, 0
v_mov_b32 v103, 0
v_mov_b32 v104, 0
v_mov_b32 v105, 0
v_mov_b32 v106, 0
v_mov_b32 v107, 0
v_mov_b32 v108, 0
v_mov_b32 v109, 0
v_mov_b32 v110, 0
v_mov_b32 v111, 0
v_mov_b32 v112, 0
v_mov_b32 v113, 0
v_mov_b32 v114, 0
v_mov_b32 v115, 0
v_mov_b32 v116, 0
v_mov_b32 v117, 0
v_mov_b32 v118, 0
v_mov_b32 v119, 0
v_mov_b32 v120, 0
v_mov_b32 v121, 0
v_mov_b32 v122, 0
v_mov_b32 v123, 0
v_mov_b32 v124, 0
v_mov_b32 v125, 0
v_mov_b32 v126, 0
v_mov_b32 v127, 0
v_mov_b32 v128, 0
v_mov_b32 v129, 0
v_mov_b32 v130, 0
v_mov_b32 v131, 0
v_mov_b32 v132, 0
v_mov_b32 v133, 0
v_mov_b32 v134, 0
v_mov_b32 v135, 0
v_mov_b32 v136, 0
v_mov_b32 v137, 0
v_mov_b32 v138, 0
v_mov_b32 v139, 0
v_mov_b32 v140, 0
v_mov_b32 v141, 0
v_mov_b32 v142, 0
v_mov_b32 v143, 0
v_mov_b32 v144, 0
v_mov_b32 v145, 0
v_mov_b32 v146, 0
v_mov_b32 v147, 0
v_mov_b32 v148, 0
v_mov_b32 v149, 0
v_mov_b32 v150, 0
v_mov_b32 v151, 0
v_mov_b32 v152, 0
v_mov_b32 v153, 0
v_mov_b32 v154, 0
v_mov_b32 v155, 0
v_mov_b32 v156, 0
v_mov_b32 v157, 0
v_mov_b32 v158, 0
v_mov_b32 v159, 0
v_mov_b32 v160, 0
v_mov_b32 v161, 0
v_mov_b32 v162, 0
v_mov_b32 v163, 0
v_mov_b32 v164, 0
v_mov_b32 v165, 0
v_mov_b32 v166, 0
v_mov_b32 v167, 0
v_mov_b32 v168, 0
v_mov_b32 v169, 0
v_mov_b32 v170, 0
v_mov_b32 v171, 0
v_mov_b32 v172, 0
v_mov_b32 v173, 0
v_mov_b32 v174, 0
v_mov_b32 v175, 0
v_mov_b32 v180, 0
v_mov_b32 v181, 0
v_mov_b32 v182, 0
v_mov_b32 v183, 0
v_mov_b32 v184, 0
v_mov_b32 v185, 0
v_mov_b32 v186, 0
v_mov_b32 v187, 0
v_mov_b32 v188, 0
v_mov_b32 v189, 0
v_mov_b32 v190, 0
v_mov_b32 v191, 0
v_mov_b32 v192, 0
v_mov_b32 v193, 0
v_mov_b32 v194, 0
v_mov_b32 v195, 0
v_mov_b32 v196, 0
v_mov_b32 v197, 0
v_mov_b32 v198, 0
v_mov_b32 v199, 0
v_and_b32 v2, 15, v1
v_bfe_u32 v3, v1, 4, 1
v_cmp_eq_u32 vcc, v2, v3
v_mov_b32 v4, s55
s_nop 0
v_cndmask_b32 v44, 0, v4, vcc
v_cndmask_b32 v45, 0, v4, vcc
v_cndmask_b32 v46, 0, v4, vcc
v_cndmask_b32 v47, 0, v4, vcc
s_waitcnt lgkmcnt(0)
s_add_u32 s24, s14, 2621440
s_addc_u32 s25, s15, 0
s_mov_b32 s26, 2621440
s_mov_b32 s27, 0x00020000
s_barrier
ds_read_b128 v[48:51], v28
ds_read_b64_tr_b16 v[52:53], v32 offset:0
ds_read_b64_tr_b16 v[54:55], v32 offset:1280
ds_read_b64_tr_b16 v[56:57], v32 offset:64
ds_read_b64_tr_b16 v[58:59], v32 offset:1344
ds_read_b64_tr_b16 v[60:61], v32 offset:128
ds_read_b64_tr_b16 v[62:63], v32 offset:1408
ds_read_b64_tr_b16 v[64:65], v32 offset:192
ds_read_b64_tr_b16 v[66:67], v32 offset:1472
ds_read_b64_tr_b16 v[68:69], v32 offset:256
ds_read_b64_tr_b16 v[70:71], v32 offset:1536
p0q_loop:
s_add_u32 s50, s50, 1
s_add_u32 s54, s54, 36864
s_cmp_ge_u32 s54, 110592
s_cselect_b32 s54, 0, s54
s_waitcnt lgkmcnt(8)
v_mfma_f32_32x32x16_bf16 v[96:111], v[52:55], v[48:51], v[96:111]
ds_read_b128 v[72:75], v29
ds_read_b64_tr_b16 v[76:77], v33 offset:0
ds_read_b64_tr_b16 v[78:79], v33 offset:1280
v_mfma_f32_16x16x32_bf16 v[180:183], v[44:47], v[52:55], v[180:183]
s_waitcnt lgkmcnt(9)
v_mfma_f32_32x32x16_bf16 v[112:127], v[56:59], v[48:51], v[112:127]
ds_read_b64_tr_b16 v[80:81], v33 offset:64
ds_read_b64_tr_b16 v[82:83], v33 offset:1344
v_mfma_f32_16x16x32_bf16 v[184:187], v[44:47], v[56:59], v[184:187]
s_waitcnt lgkmcnt(9)
v_mfma_f32_32x32x16_bf16 v[128:143], v[60:63], v[48:51], v[128:143]
ds_read_b64_tr_b16 v[84:85], v33 offset:128
ds_read_b64_tr_b16 v[86:87], v33 offset:1408
v_mfma_f32_16x16x32_bf16 v[188:191], v[44:47], v[60:63], v[188:191]
s_waitcnt lgkmcnt(9)
v_mfma_f32_32x32x16_bf16 v[144:159], v[64:67], v[48:51], v[144:159]
ds_read_b64_tr_b16 v[88:89], v33 offset:192
ds_read_b64_tr_b16 v[90:91], v33 offset:1472
v_add_u32 v28, s54, v20
v_mfma_f32_16x16x32_bf16 v[192:195], v[44:47], v[64:67], v[192:195]
s_waitcnt lgkmcnt(9)
v_mfma_f32_32x32x16_bf16 v[160:175], v[68:71], v[48:51], v[160:175]
ds_read_b64_tr_b16 v[92:93], v33 offset:256
ds_read_b64_tr_b16 v[94:95], v33 offset:1536
v_add_u32 v32, s54, v24
v_mfma_f32_16x16x32_bf16 v[196:199], v[44:47], v[68:71], v[196:199]
s_waitcnt lgkmcnt(8)
v_mfma_f32_32x32x16_bf16 v[96:111], v[76:79], v[72:75], v[96:111]
ds_read_b128 v[48:51], v30
ds_read_b64_tr_b16 v[52:53], v34 offset:0
ds_read_b64_tr_b16 v[54:55], v34 offset:1280
s_waitcnt lgkmcnt(9)
v_mfma_f32_32x32x16_bf16 v[112:127], v[80:83], v[72:75], v[112:127]
ds_read_b64_tr_b16 v[56:57], v34 offset:64
ds_read_b64_tr_b16 v[58:59], v34 offset:1344
s_waitcnt lgkmcnt(9)
v_mfma_f32_32x32x16_bf16 v[128:143], v[84:87], v[72:75], v[128:143]
ds_read_b64_tr_b16 v[60:61], v34 offset:128
ds_read_b64_tr_b16 v[62:63], v34 offset:1408
s_waitcnt lgkmcnt(9)
v_mfma_f32_32x32x16_bf16 v[144:159], v[88:91], v[72:75], v[144:159]
ds_read_b64_tr_b16 v[64:65], v34 offset:192
ds_read_b64_tr_b16 v[66:67], v34 offset:1472
v_add_u32 v29, s54, v21
s_waitcnt lgkmcnt(9)
v_mfma_f32_32x32x16_bf16 v[160:175], v[92:95], v[72:75], v[160:175]
ds_read_b64_tr_b16 v[68:69], v34 offset:256
ds_read_b64_tr_b16 v[70:71], v34 offset:1536
v_add_u32 v33, s54, v25
s_waitcnt lgkmcnt(8)
v_mfma_f32_32x32x16_bf16 v[96:111], v[52:55], v[48:51], v[96:111]
ds_read_b128 v[72:75], v31
ds_read_b64_tr_b16 v[76:77], v35 offset:0
ds_read_b64_tr_b16 v[78:79], v35 offset:1280
ds_read_b64_tr_b16 v[80:81], v35 offset:64
s_waitcnt lgkmcnt(10)
v_mfma_f32_32x32x16_bf16 v[112:127], v[56:59], v[48:51], v[112:127]
ds_read_b64_tr_b16 v[82:83], v35 offset:1344
ds_read_b64_tr_b16 v[84:85], v35 offset:128
ds_read_b64_tr_b16 v[86:87], v35 offset:1408
ds_read_b64_tr_b16 v[88:89], v35 offset:192
s_waitcnt lgkmcnt(12)
v_mfma_f32_32x32x16_bf16 v[128:143], v[60:63], v[48:51], v[128:143]
ds_read_b64_tr_b16 v[90:91], v35 offset:1472
ds_read_b64_tr_b16 v[92:93], v35 offset:256
ds_read_b64_tr_b16 v[94:95], v35 offset:1536
s_waitcnt lgkmcnt(13)
v_mfma_f32_32x32x16_bf16 v[144:159], v[64:67], v[48:51], v[144:159]
v_add_u32 v30, s54, v22
s_waitcnt lgkmcnt(11)
v_mfma_f32_32x32x16_bf16 v[160:175], v[68:71], v[48:51], v[160:175]
v_add_u32 v34, s54, v26
s_waitcnt lgkmcnt(0)
s_barrier
v_mfma_f32_32x32x16_bf16 v[96:111], v[76:79], v[72:75], v[96:111]
ds_read_b128 v[48:51], v28
ds_read_b64_tr_b16 v[52:53], v32 offset:0
ds_read_b64_tr_b16 v[54:55], v32 offset:1280
v_mfma_f32_32x32x16_bf16 v[112:127], v[80:83], v[72:75], v[112:127]
ds_read_b64_tr_b16 v[56:57], v32 offset:64
ds_read_b64_tr_b16 v[58:59], v32 offset:1344
v_mfma_f32_32x32x16_bf16 v[128:143], v[84:87], v[72:75], v[128:143]
ds_read_b64_tr_b16 v[60:61], v32 offset:128
ds_read_b64_tr_b16 v[62:63], v32 offset:1408
v_mfma_f32_32x32x16_bf16 v[144:159], v[88:91], v[72:75], v[144:159]
ds_read_b64_tr_b16 v[64:65], v32 offset:192
ds_read_b64_tr_b16 v[66:67], v32 offset:1472
v_add_u32 v31, s54, v23
v_mfma_f32_32x32x16_bf16 v[160:175], v[92:95], v[72:75], v[160:175]
ds_read_b64_tr_b16 v[68:69], v32 offset:256
ds_read_b64_tr_b16 v[70:71], v32 offset:1536
v_add_u32 v35, s54, v27
s_cmp_lt_u32 s50, 10
s_cbranch_scc1 p0q_loop
s_waitcnt lgkmcnt(0)
s_nop 2
v_lshlrev_b32 v2, 2, v1
s_mul_i32 s45, s42, 768
v_add_u32 v3, s45, v2
v_add_u32 v3, 139264, v3
s_mov_b64 exec, 0xffff
ds_write2_b32 v3, v180, v181 offset0:0 offset1:16
ds_write2_b32 v3, v184, v185 offset0:32 offset1:48
ds_write2_b32 v3, v188, v189 offset0:64 offset1:80
ds_write2_b32 v3, v192, v193 offset0:96 offset1:112
ds_write2_b32 v3, v196, v197 offset0:128 offset1:144
s_mov_b64 exec, -1
v_and_b32 v2, 31, v1
v_lshlrev_b32 v2, 2, v2
v_add_u32 v2, 139264, v2
s_lshl_b32 s45, s42, 8
v_add_u32 v3, s45, v2
ds_read_b32 v37, v3 offset:3072
ds_read_b32 v39, v3 offset:3200
s_waitcnt vmcnt(0) lgkmcnt(0)
s_barrier
ds_read_b32 v48, v2 offset:0
ds_read_b32 v49, v2 offset:768
ds_read_b32 v50, v2 offset:1536
ds_read_b32 v51, v2 offset:2304
ds_read_b32 v52, v2 offset:128
ds_read_b32 v53, v2 offset:896
ds_read_b32 v54, v2 offset:1664
ds_read_b32 v55, v2 offset:2432
ds_read_b32 v56, v2 offset:256
ds_read_b32 v57, v2 offset:1024
ds_read_b32 v58, v2 offset:1792
ds_read_b32 v59, v2 offset:2560
ds_read_b32 v60, v2 offset:384
ds_read_b32 v61, v2 offset:1152
ds_read_b32 v62, v2 offset:1920
ds_read_b32 v63, v2 offset:2688
ds_read_b32 v64, v2 offset:512
ds_read_b32 v65, v2 offset:1280
ds_read_b32 v66, v2 offset:2048
ds_read_b32 v67, v2 offset:2816
v_lshrrev_b32 v5, 16, v37
v_or_b32 v72, v5, v37
v_xor_b32 v72, 0x80008000, v72
v_mov_b32 v73, 0
v_mov_b32 v74, 0
v_mov_b32 v75, 0
v_cmp_gt_u32 vcc, 32, v1
s_waitcnt lgkmcnt(0)
v_add_f32 v48, v48, v49
v_add_f32 v50, v50, v51
v_add_f32 v48, v48, v50
v_cvt_pk_bf16_f32 v49, v48, v48
v_and_b32 v49, 0xffff0000, v49
v_sub_f32 v50, v48, v49
v_cvt_pk_bf16_f32 v48, v49, v50
v_cndmask_b32 v48, 0, v48, vcc
v_mov_b32 v49, 0
v_mov_b32 v50, 0
v_mov_b32 v51, 0
v_add_f32 v52, v52, v53
v_add_f32 v54, v54, v55
v_add_f32 v52, v52, v54
v_cvt_pk_bf16_f32 v53, v52, v52
v_and_b32 v53, 0xffff0000, v53
v_sub_f32 v54, v52, v53
v_cvt_pk_bf16_f32 v52, v53, v54
v_cndmask_b32 v52, 0, v52, vcc
v_mov_b32 v53, 0
v_mov_b32 v54, 0
v_mov_b32 v55, 0
v_add_f32 v56, v56, v57
v_add_f32 v58, v58, v59
v_add_f32 v56, v56, v58
v_cvt_pk_bf16_f32 v57, v56, v56
v_and_b32 v57, 0xffff0000, v57
v_sub_f32 v58, v56, v57
v_cvt_pk_bf16_f32 v56, v57, v58
v_cndmask_b32 v56, 0, v56, vcc
v_mov_b32 v57, 0
v_mov_b32 v58, 0
v_mov_b32 v59, 0
v_add_f32 v60, v60, v61
v_add_f32 v62, v62, v63
v_add_f32 v60, v60, v62
v_cvt_pk_bf16_f32 v61, v60, v60
v_and_b32 v61, 0xffff0000, v61
v_sub_f32 v62, v60, v61
v_cvt_pk_bf16_f32 v60, v61, v62
v_cndmask_b32 v60, 0, v60, vcc
v_mov_b32 v61, 0
v_mov_b32 v62, 0
v_mov_b32 v63, 0
v_add_f32 v64, v64, v65
v_add_f32 v66, v66, v67
v_add_f32 v64, v64, v66
v_cvt_pk_bf16_f32 v65, v64, v64
v_and_b32 v65, 0xffff0000, v65
v_sub_f32 v66, v64, v65
v_cvt_pk_bf16_f32 v64, v65, v66
v_cndmask_b32 v64, 0, v64, vcc
v_mov_b32 v65, 0
v_mov_b32 v66, 0
v_mov_b32 v67, 0
v_mfma_f32_32x32x16_bf16 v[96:111], v[48:51], v[72:75], v[96:111]
v_mfma_f32_32x32x16_bf16 v[112:127], v[52:55], v[72:75], v[112:127]
v_mfma_f32_32x32x16_bf16 v[128:143], v[56:59], v[72:75], v[128:143]
v_mfma_f32_32x32x16_bf16 v[144:159], v[60:63], v[72:75], v[144:159]
v_mfma_f32_32x32x16_bf16 v[160:175], v[64:67], v[72:75], v[160:175]
s_mov_b32 s62, 0x358637bd
v_mov_b32 v8, s62
v_mov_b32 v9, s62
v_mov_b32 v10, 0x3fb8aa3b
v_mov_b32 v11, v10
v_mov_b32 v38, v39
s_lshl_b32 s45, s44, 7
s_lshl_b32 s46, s43, 2
s_add_u32 s45, s45, s46
s_add_u32 s45, s45, s42
s_mul_i32 s45, s45, 5120
v_lshlrev_b32 v2, 4, v1
v_add_u32 v3, 4096, v2
s_add_u32 s46, s45, 327680
v_pk_fma_f32 v[96:97], v[96:97], v[38:39], v[8:9]
v_pk_fma_f32 v[98:99], v[98:99], v[38:39], v[8:9]
v_pk_mul_f32 v[4:5], v[96:97], v[10:11]
v_pk_mul_f32 v[6:7], v[98:99], v[10:11]
v_exp_f32 v4, v4 clamp
v_max_f32 v96, s62, v96
v_exp_f32 v5, v5 clamp
v_max_f32 v97, s62, v97
v_exp_f32 v6, v6 clamp
v_max_f32 v98, s62, v98
v_exp_f32 v7, v7 clamp
v_max_f32 v99, s62, v99
v_pk_add_f32 v[96:97], v[96:97], v[4:5]
v_pk_add_f32 v[98:99], v[98:99], v[6:7]
v_pk_fma_f32 v[100:101], v[100:101], v[38:39], v[8:9]
v_pk_fma_f32 v[102:103], v[102:103], v[38:39], v[8:9]
v_pk_mul_f32 v[4:5], v[100:101], v[10:11]
v_pk_mul_f32 v[6:7], v[102:103], v[10:11]
v_exp_f32 v4, v4 clamp
v_max_f32 v100, s62, v100
v_exp_f32 v5, v5 clamp
v_max_f32 v101, s62, v101
v_exp_f32 v6, v6 clamp
v_max_f32 v102, s62, v102
v_exp_f32 v7, v7 clamp
v_max_f32 v103, s62, v103
v_pk_add_f32 v[100:101], v[100:101], v[4:5]
v_pk_add_f32 v[102:103], v[102:103], v[6:7]
v_cvt_pk_bf16_f32 v176, v96, v97
v_cvt_pk_bf16_f32 v177, v98, v99
v_cvt_pk_bf16_f32 v178, v100, v101
v_cvt_pk_bf16_f32 v179, v102, v103
s_nop 0
v_permlane32_swap_b32 v176, v178
v_permlane32_swap_b32 v177, v179
buffer_store_dwordx4 v[176:179], v2, s[24:27], s45 offen offset:0 sc1
v_pk_fma_f32 v[104:105], v[104:105], v[38:39], v[8:9]
v_pk_fma_f32 v[106:107], v[106:107], v[38:39], v[8:9]
v_pk_mul_f32 v[4:5], v[104:105], v[10:11]
v_pk_mul_f32 v[6:7], v[106:107], v[10:11]
v_exp_f32 v4, v4 clamp
v_max_f32 v104, s62, v104
v_exp_f32 v5, v5 clamp
v_max_f32 v105, s62, v105
v_exp_f32 v6, v6 clamp
v_max_f32 v106, s62, v106
v_exp_f32 v7, v7 clamp
v_max_f32 v107, s62, v107
v_pk_add_f32 v[104:105], v[104:105], v[4:5]
v_pk_add_f32 v[106:107], v[106:107], v[6:7]
v_pk_fma_f32 v[108:109], v[108:109], v[38:39], v[8:9]
v_pk_fma_f32 v[110:111], v[110:111], v[38:39], v[8:9]
v_pk_mul_f32 v[4:5], v[108:109], v[10:11]
v_pk_mul_f32 v[6:7], v[110:111], v[10:11]
v_exp_f32 v4, v4 clamp
v_max_f32 v108, s62, v108
v_exp_f32 v5, v5 clamp
v_max_f32 v109, s62, v109
v_exp_f32 v6, v6 clamp
v_max_f32 v110, s62, v110
v_exp_f32 v7, v7 clamp
v_max_f32 v111, s62, v111
v_pk_add_f32 v[108:109], v[108:109], v[4:5]
v_pk_add_f32 v[110:111], v[110:111], v[6:7]
v_cvt_pk_bf16_f32 v180, v104, v105
v_cvt_pk_bf16_f32 v181, v106, v107
v_cvt_pk_bf16_f32 v182, v108, v109
v_cvt_pk_bf16_f32 v183, v110, v111
s_nop 0
v_permlane32_swap_b32 v180, v182
v_permlane32_swap_b32 v181, v183
buffer_store_dwordx4 v[180:183], v2, s[24:27], s45 offen offset:1024 sc1
v_pk_fma_f32 v[112:113], v[112:113], v[38:39], v[8:9]
v_pk_fma_f32 v[114:115], v[114:115], v[38:39], v[8:9]
v_pk_mul_f32 v[4:5], v[112:113], v[10:11]
v_pk_mul_f32 v[6:7], v[114:115], v[10:11]
v_exp_f32 v4, v4 clamp
v_max_f32 v112, s62, v112
v_exp_f32 v5, v5 clamp
v_max_f32 v113, s62, v113
v_exp_f32 v6, v6 clamp
v_max_f32 v114, s62, v114
v_exp_f32 v7, v7 clamp
v_max_f32 v115, s62, v115
v_pk_add_f32 v[112:113], v[112:113], v[4:5]
v_pk_add_f32 v[114:115], v[114:115], v[6:7]
v_pk_fma_f32 v[116:117], v[116:117], v[38:39], v[8:9]
v_pk_fma_f32 v[118:119], v[118:119], v[38:39], v[8:9]
v_pk_mul_f32 v[4:5], v[116:117], v[10:11]
v_pk_mul_f32 v[6:7], v[118:119], v[10:11]
v_exp_f32 v4, v4 clamp
v_max_f32 v116, s62, v116
v_exp_f32 v5, v5 clamp
v_max_f32 v117, s62, v117
v_exp_f32 v6, v6 clamp
v_max_f32 v118, s62, v118
v_exp_f32 v7, v7 clamp
v_max_f32 v119, s62, v119
v_pk_add_f32 v[116:117], v[116:117], v[4:5]
v_pk_add_f32 v[118:119], v[118:119], v[6:7]
v_cvt_pk_bf16_f32 v184, v112, v113
v_cvt_pk_bf16_f32 v185, v114, v115
v_cvt_pk_bf16_f32 v186, v116, v117
v_cvt_pk_bf16_f32 v187, v118, v119
s_nop 0
v_permlane32_swap_b32 v184, v186
v_permlane32_swap_b32 v185, v187
buffer_store_dwordx4 v[184:187], v2, s[24:27], s45 offen offset:2048 sc1
v_pk_fma_f32 v[120:121], v[120:121], v[38:39], v[8:9]
v_pk_fma_f32 v[122:123], v[122:123], v[38:39], v[8:9]
v_pk_mul_f32 v[4:5], v[120:121], v[10:11]
v_pk_mul_f32 v[6:7], v[122:123], v[10:11]
v_exp_f32 v4, v4 clamp
v_max_f32 v120, s62, v120
v_exp_f32 v5, v5 clamp
v_max_f32 v121, s62, v121
v_exp_f32 v6, v6 clamp
v_max_f32 v122, s62, v122
v_exp_f32 v7, v7 clamp
v_max_f32 v123, s62, v123
v_pk_add_f32 v[120:121], v[120:121], v[4:5]
v_pk_add_f32 v[122:123], v[122:123], v[6:7]
v_pk_fma_f32 v[124:125], v[124:125], v[38:39], v[8:9]
v_pk_fma_f32 v[126:127], v[126:127], v[38:39], v[8:9]
v_pk_mul_f32 v[4:5], v[124:125], v[10:11]
v_pk_mul_f32 v[6:7], v[126:127], v[10:11]
v_exp_f32 v4, v4 clamp
v_max_f32 v124, s62, v124
v_exp_f32 v5, v5 clamp
v_max_f32 v125, s62, v125
v_exp_f32 v6, v6 clamp
v_max_f32 v126, s62, v126
v_exp_f32 v7, v7 clamp
v_max_f32 v127, s62, v127
v_pk_add_f32 v[124:125], v[124:125], v[4:5]
v_pk_add_f32 v[126:127], v[126:127], v[6:7]
v_cvt_pk_bf16_f32 v188, v120, v121
v_cvt_pk_bf16_f32 v189, v122, v123
v_cvt_pk_bf16_f32 v190, v124, v125
v_cvt_pk_bf16_f32 v191, v126, v127
s_nop 0
v_permlane32_swap_b32 v188, v190
v_permlane32_swap_b32 v189, v191
buffer_store_dwordx4 v[188:191], v2, s[24:27], s45 offen offset:3072 sc1
v_pk_fma_f32 v[128:129], v[128:129], v[38:39], v[8:9]
v_pk_fma_f32 v[130:131], v[130:131], v[38:39], v[8:9]
v_pk_mul_f32 v[4:5], v[128:129], v[10:11]
v_pk_mul_f32 v[6:7], v[130:131], v[10:11]
v_exp_f32 v4, v4 clamp
v_max_f32 v128, s62, v128
v_exp_f32 v5, v5 clamp
v_max_f32 v129, s62, v129
v_exp_f32 v6, v6 clamp
v_max_f32 v130, s62, v130
v_exp_f32 v7, v7 clamp
v_max_f32 v131, s62, v131
v_pk_add_f32 v[128:129], v[128:129], v[4:5]
v_pk_add_f32 v[130:131], v[130:131], v[6:7]
v_pk_fma_f32 v[132:133], v[132:133], v[38:39], v[8:9]
v_pk_fma_f32 v[134:135], v[134:135], v[38:39], v[8:9]
v_pk_mul_f32 v[4:5], v[132:133], v[10:11]
v_pk_mul_f32 v[6:7], v[134:135], v[10:11]
v_exp_f32 v4, v4 clamp
v_max_f32 v132, s62, v132
v_exp_f32 v5, v5 clamp
v_max_f32 v133, s62, v133
v_exp_f32 v6, v6 clamp
v_max_f32 v134, s62, v134
v_exp_f32 v7, v7 clamp
v_max_f32 v135, s62, v135
v_pk_add_f32 v[132:133], v[132:133], v[4:5]
v_pk_add_f32 v[134:135], v[134:135], v[6:7]
v_cvt_pk_bf16_f32 v192, v128, v129
v_cvt_pk_bf16_f32 v193, v130, v131
v_cvt_pk_bf16_f32 v194, v132, v133
v_cvt_pk_bf16_f32 v195, v134, v135
s_nop 0
v_permlane32_swap_b32 v192, v194
v_permlane32_swap_b32 v193, v195
buffer_store_dwordx4 v[192:195], v3, s[24:27], s45 offen offset:0 sc1
v_pk_fma_f32 v[136:137], v[136:137], v[38:39], v[8:9]
v_pk_fma_f32 v[138:139], v[138:139], v[38:39], v[8:9]
v_pk_mul_f32 v[4:5], v[136:137], v[10:11]
v_pk_mul_f32 v[6:7], v[138:139], v[10:11]
v_exp_f32 v4, v4 clamp
v_max_f32 v136, s62, v136
v_exp_f32 v5, v5 clamp
v_max_f32 v137, s62, v137
v_exp_f32 v6, v6 clamp
v_max_f32 v138, s62, v138
v_exp_f32 v7, v7 clamp
v_max_f32 v139, s62, v139
v_pk_add_f32 v[136:137], v[136:137], v[4:5]
v_pk_add_f32 v[138:139], v[138:139], v[6:7]
v_pk_fma_f32 v[140:141], v[140:141], v[38:39], v[8:9]
v_pk_fma_f32 v[142:143], v[142:143], v[38:39], v[8:9]
v_pk_mul_f32 v[4:5], v[140:141], v[10:11]
v_pk_mul_f32 v[6:7], v[142:143], v[10:11]
v_exp_f32 v4, v4 clamp
v_max_f32 v140, s62, v140
v_exp_f32 v5, v5 clamp
v_max_f32 v141, s62, v141
v_exp_f32 v6, v6 clamp
v_max_f32 v142, s62, v142
v_exp_f32 v7, v7 clamp
v_max_f32 v143, s62, v143
v_pk_add_f32 v[140:141], v[140:141], v[4:5]
v_pk_add_f32 v[142:143], v[142:143], v[6:7]
v_cvt_pk_bf16_f32 v196, v136, v137
v_cvt_pk_bf16_f32 v197, v138, v139
v_cvt_pk_bf16_f32 v198, v140, v141
v_cvt_pk_bf16_f32 v199, v142, v143
s_nop 0
v_permlane32_swap_b32 v196, v198
v_permlane32_swap_b32 v197, v199
buffer_store_dwordx4 v[196:199], v2, s[24:27], s46 offen offset:0 sc1
v_pk_fma_f32 v[144:145], v[144:145], v[38:39], v[8:9]
v_pk_fma_f32 v[146:147], v[146:147], v[38:39], v[8:9]
v_pk_mul_f32 v[4:5], v[144:145], v[10:11]
v_pk_mul_f32 v[6:7], v[146:147], v[10:11]
v_exp_f32 v4, v4 clamp
v_max_f32 v144, s62, v144
v_exp_f32 v5, v5 clamp
v_max_f32 v145, s62, v145
v_exp_f32 v6, v6 clamp
v_max_f32 v146, s62, v146
v_exp_f32 v7, v7 clamp
v_max_f32 v147, s62, v147
v_pk_add_f32 v[144:145], v[144:145], v[4:5]
v_pk_add_f32 v[146:147], v[146:147], v[6:7]
v_pk_fma_f32 v[148:149], v[148:149], v[38:39], v[8:9]
v_pk_fma_f32 v[150:151], v[150:151], v[38:39], v[8:9]
v_pk_mul_f32 v[4:5], v[148:149], v[10:11]
v_pk_mul_f32 v[6:7], v[150:151], v[10:11]
v_exp_f32 v4, v4 clamp
v_max_f32 v148, s62, v148
v_exp_f32 v5, v5 clamp
v_max_f32 v149, s62, v149
v_exp_f32 v6, v6 clamp
v_max_f32 v150, s62, v150
v_exp_f32 v7, v7 clamp
v_max_f32 v151, s62, v151
v_pk_add_f32 v[148:149], v[148:149], v[4:5]
v_pk_add_f32 v[150:151], v[150:151], v[6:7]
v_cvt_pk_bf16_f32 v200, v144, v145
v_cvt_pk_bf16_f32 v201, v146, v147
v_cvt_pk_bf16_f32 v202, v148, v149
v_cvt_pk_bf16_f32 v203, v150, v151
s_nop 0
v_permlane32_swap_b32 v200, v202
v_permlane32_swap_b32 v201, v203
buffer_store_dwordx4 v[200:203], v2, s[24:27], s46 offen offset:1024 sc1
v_pk_fma_f32 v[152:153], v[152:153], v[38:39], v[8:9]
v_pk_fma_f32 v[154:155], v[154:155], v[38:39], v[8:9]
v_pk_mul_f32 v[4:5], v[152:153], v[10:11]
v_pk_mul_f32 v[6:7], v[154:155], v[10:11]
v_exp_f32 v4, v4 clamp
v_max_f32 v152, s62, v152
v_exp_f32 v5, v5 clamp
v_max_f32 v153, s62, v153
v_exp_f32 v6, v6 clamp
v_max_f32 v154, s62, v154
v_exp_f32 v7, v7 clamp
v_max_f32 v155, s62, v155
v_pk_add_f32 v[152:153], v[152:153], v[4:5]
v_pk_add_f32 v[154:155], v[154:155], v[6:7]
v_pk_fma_f32 v[156:157], v[156:157], v[38:39], v[8:9]
v_pk_fma_f32 v[158:159], v[158:159], v[38:39], v[8:9]
v_pk_mul_f32 v[4:5], v[156:157], v[10:11]
v_pk_mul_f32 v[6:7], v[158:159], v[10:11]
v_exp_f32 v4, v4 clamp
v_max_f32 v156, s62, v156
v_exp_f32 v5, v5 clamp
v_max_f32 v157, s62, v157
v_exp_f32 v6, v6 clamp
v_max_f32 v158, s62, v158
v_exp_f32 v7, v7 clamp
v_max_f32 v159, s62, v159
v_pk_add_f32 v[156:157], v[156:157], v[4:5]
v_pk_add_f32 v[158:159], v[158:159], v[6:7]
v_cvt_pk_bf16_f32 v204, v152, v153
v_cvt_pk_bf16_f32 v205, v154, v155
v_cvt_pk_bf16_f32 v206, v156, v157
v_cvt_pk_bf16_f32 v207, v158, v159
s_nop 0
v_permlane32_swap_b32 v204, v206
v_permlane32_swap_b32 v205, v207
buffer_store_dwordx4 v[204:207], v2, s[24:27], s46 offen offset:2048 sc1
v_pk_fma_f32 v[160:161], v[160:161], v[38:39], v[8:9]
v_pk_fma_f32 v[162:163], v[162:163], v[38:39], v[8:9]
v_pk_mul_f32 v[4:5], v[160:161], v[10:11]
v_pk_mul_f32 v[6:7], v[162:163], v[10:11]
v_exp_f32 v4, v4 clamp
v_max_f32 v160, s62, v160
v_exp_f32 v5, v5 clamp
v_max_f32 v161, s62, v161
v_exp_f32 v6, v6 clamp
v_max_f32 v162, s62, v162
v_exp_f32 v7, v7 clamp
v_max_f32 v163, s62, v163
v_pk_add_f32 v[160:161], v[160:161], v[4:5]
v_pk_add_f32 v[162:163], v[162:163], v[6:7]
v_pk_fma_f32 v[164:165], v[164:165], v[38:39], v[8:9]
v_pk_fma_f32 v[166:167], v[166:167], v[38:39], v[8:9]
v_pk_mul_f32 v[4:5], v[164:165], v[10:11]
v_pk_mul_f32 v[6:7], v[166:167], v[10:11]
v_exp_f32 v4, v4 clamp
v_max_f32 v164, s62, v164
v_exp_f32 v5, v5 clamp
v_max_f32 v165, s62, v165
v_exp_f32 v6, v6 clamp
v_max_f32 v166, s62, v166
v_exp_f32 v7, v7 clamp
v_max_f32 v167, s62, v167
v_pk_add_f32 v[164:165], v[164:165], v[4:5]
v_pk_add_f32 v[166:167], v[166:167], v[6:7]
v_cvt_pk_bf16_f32 v208, v160, v161
v_cvt_pk_bf16_f32 v209, v162, v163
v_cvt_pk_bf16_f32 v210, v164, v165
v_cvt_pk_bf16_f32 v211, v166, v167
s_nop 0
v_permlane32_swap_b32 v208, v210
v_permlane32_swap_b32 v209, v211
buffer_store_dwordx4 v[208:211], v2, s[24:27], s46 offen offset:3072 sc1
v_pk_fma_f32 v[168:169], v[168:169], v[38:39], v[8:9]
v_pk_fma_f32 v[170:171], v[170:171], v[38:39], v[8:9]
v_pk_mul_f32 v[4:5], v[168:169], v[10:11]
v_pk_mul_f32 v[6:7], v[170:171], v[10:11]
v_exp_f32 v4, v4 clamp
v_max_f32 v168, s62, v168
v_exp_f32 v5, v5 clamp
v_max_f32 v169, s62, v169
v_exp_f32 v6, v6 clamp
v_max_f32 v170, s62, v170
v_exp_f32 v7, v7 clamp
v_max_f32 v171, s62, v171
v_pk_add_f32 v[168:169], v[168:169], v[4:5]
v_pk_add_f32 v[170:171], v[170:171], v[6:7]
v_pk_fma_f32 v[172:173], v[172:173], v[38:39], v[8:9]
v_pk_fma_f32 v[174:175], v[174:175], v[38:39], v[8:9]
v_pk_mul_f32 v[4:5], v[172:173], v[10:11]
v_pk_mul_f32 v[6:7], v[174:175], v[10:11]
v_exp_f32 v4, v4 clamp
v_max_f32 v172, s62, v172
v_exp_f32 v5, v5 clamp
v_max_f32 v173, s62, v173
v_exp_f32 v6, v6 clamp
v_max_f32 v174, s62, v174
v_exp_f32 v7, v7 clamp
v_max_f32 v175, s62, v175
v_pk_add_f32 v[172:173], v[172:173], v[4:5]
v_pk_add_f32 v[174:175], v[174:175], v[6:7]
v_cvt_pk_bf16_f32 v212, v168, v169
v_cvt_pk_bf16_f32 v213, v170, v171
v_cvt_pk_bf16_f32 v214, v172, v173
v_cvt_pk_bf16_f32 v215, v174, v175
s_nop 0
v_permlane32_swap_b32 v212, v214
v_permlane32_swap_b32 v213, v215
buffer_store_dwordx4 v[212:215], v3, s[24:27], s46 offen offset:0 sc1
s_branch cB
r_aux:
s_lshl_b32 s96, s46, 1
s_add_u32 s96, s96, s45
s_sub_u32 s96, s96, 6
s_mov_b32 s98, 3
s_sub_u32 s44, s41, 24
s_lshl_b32 s43, s40, 3
s_add_u32 s43, s43, s44
s_lshl_b32 s45, s43, 5
s_lshl_b32 s46, s42, 2
s_add_u32 s45, s45, s46
v_lshrrev_b32 v2, 4, v1
v_add_u32 v3, s45, v2
v_mul_u32_u24 v3, 1280, v3
v_and_b32 v4, 15, v1
v_lshl_add_u32 v3, v4, 4, v3
s_waitcnt lgkmcnt(0)
s_mov_b32 s16, s4
s_mov_b32 s17, s5
s_mov_b32 s18, 2621440
s_mov_b32 s19, 0x00020000
buffer_load_dwordx4 v[16:19], v3, s[16:19], 0 offen offset:0
buffer_load_dwordx4 v[20:23], v3, s[16:19], 0 offen offset:256
buffer_load_dwordx4 v[24:27], v3, s[16:19], 0 offen offset:512
buffer_load_dwordx4 v[28:31], v3, s[16:19], 0 offen offset:768
buffer_load_dwordx4 v[32:35], v3, s[16:19], 0 offen offset:1024
s_add_u32 s24, s14, 12582912
s_addc_u32 s25, s15, 0
s_mov_b32 s26, 2637824
s_mov_b32 s27, 0x00020000
s_mov_b32 s28, s12
s_mov_b32 s29, s13
s_mov_b32 s30, 819200
s_mov_b32 s31, 0x00020000
s_mul_i32 s48, s96, 102400
s_mul_i32 s50, s97, 160
s_add_u32 s48, s48, s50
v_add_u32 v5, 0, v0
v_mul_u32_u24 v6, 6554, v5
v_lshrrev_b32 v6, 16, v6
v_mul_u32_u24 v6, 1120, v6
v_lshl_add_u32 v6, v5, 4, v6
s_lshl_b32 s50, s42, 10
s_add_u32 m0, s50, 131072
s_nop 0
buffer_load_dwordx4 v6, s[28:31], s48 offen lds
v_add_u32 v5, 512, v0
v_mul_u32_u24 v6, 6554, v5
v_lshrrev_b32 v6, 16, v6
v_mul_u32_u24 v6, 1120, v6
v_lshl_add_u32 v6, v5, 4, v6
v_mov_b32 v7, 1073741824
v_cmp_gt_u32 vcc, 800, v5
s_nop 1
v_cndmask_b32 v6, v7, v6, vcc
s_lshl_b32 s50, s42, 10
s_add_u32 m0, s50, 139264
s_nop 0
buffer_load_dwordx4 v6, s[28:31], s48 offen lds
s_mov_b32 s36, s84
s_mov_b32 s37, s85
s_mov_b32 s38, 7077888
s_mov_b32 s39, 0x00020000
s_and_b32 s50, s41, 3
s_mul_i32 s50, s50, 256
v_add_u32 v5, s50, v0
v_mul_u32_u24 v5, 3456, v5
v_mov_b32 v7, 1073741824
v_cmp_gt_u32 vcc, 256, v0
s_nop 1
v_cndmask_b32 v5, v7, v5, vcc
s_lshl_b32 s50, s96, 7
buffer_load_dword v240, v5, s[36:39], s50 offen
s_mov_b32 s55, 0x3f803f80
v_add_u32 v5, s46, v2
v_mul_u32_u24 v5, 1312, v5
v_lshl_add_u32 v5, v4, 4, v5
v_bfe_u32 v3, v1, 2, 2
v_and_b32 v6, 3, v1
v_lshl_add_u32 v7, v2, 3, v3
v_mul_u32_u24 v7, 1312, v7
v_lshl_add_u32 v7, v6, 3, v7
s_lshl_b32 s50, s42, 5
v_add_u32 v7, s50, v7
v_lshlrev_b32 v40, 6, v4
v_lshl_add_u32 v40, v2, 4, v40
s_mul_i32 s50, s43, 40960
s_lshl_b32 s51, s42, 10
s_add_u32 s50, s50, s51
s_waitcnt vmcnt(3)
v_mov_b32 v8, 0
v_mov_b32 v9, 0
v_mov_b32 v10, 0
v_mov_b32 v11, 0
v_dot2c_f32_bf16 v8, s55, v16
v_dot2c_f32_bf16 v10, v16, v16
v_dot2c_f32_bf16 v9, s55, v17
v_dot2c_f32_bf16 v11, v17, v17
v_dot2c_f32_bf16 v8, s55, v18
v_dot2c_f32_bf16 v10, v18, v18
v_dot2c_f32_bf16 v9, s55, v19
v_dot2c_f32_bf16 v11, v19, v19
v_dot2c_f32_bf16 v8, s55, v20
v_dot2c_f32_bf16 v10, v20, v20
v_dot2c_f32_bf16 v9, s55, v21
v_dot2c_f32_bf16 v11, v21, v21
v_dot2c_f32_bf16 v8, s55, v22
v_dot2c_f32_bf16 v10, v22, v22
v_dot2c_f32_bf16 v9, s55, v23
v_dot2c_f32_bf16 v11, v23, v23
v_dot2c_f32_bf16 v8, s55, v24
v_dot2c_f32_bf16 v10, v24, v24
v_dot2c_f32_bf16 v9, s55, v25
v_dot2c_f32_bf16 v11, v25, v25
v_dot2c_f32_bf16 v8, s55, v26
v_dot2c_f32_bf16 v10, v26, v26
v_dot2c_f32_bf16 v9, s55, v27
v_dot2c_f32_bf16 v11, v27, v27
v_dot2c_f32_bf16 v8, s55, v28
v_dot2c_f32_bf16 v10, v28, v28
v_dot2c_f32_bf16 v9, s55, v29
v_dot2c_f32_bf16 v11, v29, v29
v_dot2c_f32_bf16 v8, s55, v30
v_dot2c_f32_bf16 v10, v30, v30
v_dot2c_f32_bf16 v9, s55, v31
v_dot2c_f32_bf16 v11, v31, v31
v_dot2c_f32_bf16 v8, s55, v32
v_dot2c_f32_bf16 v10, v32, v32
v_dot2c_f32_bf16 v9, s55, v33
v_dot2c_f32_bf16 v11, v33, v33
v_dot2c_f32_bf16 v8, s55, v34
v_dot2c_f32_bf16 v10, v34, v34
v_dot2c_f32_bf16 v9, s55, v35
v_dot2c_f32_bf16 v11, v35, v35
s_nop 1
v_add_f32 v8, v8, v9
v_add_f32 v10, v10, v11
s_nop 0
v_add_f32_dpp v8, v8, v8 quad_perm:[1,0,3,2] row_mask:0xf bank_mask:0xf
v_add_f32_dpp v10, v10, v10 quad_perm:[1,0,3,2] row_mask:0xf bank_mask:0xf
s_nop 0
v_add_f32_dpp v8, v8, v8 quad_perm:[2,3,0,1] row_mask:0xf bank_mask:0xf
v_add_f32_dpp v10, v10, v10 quad_perm:[2,3,0,1] row_mask:0xf bank_mask:0xf
s_nop 0
v_add_f32_dpp v8, v8, v8 row_half_mirror row_mask:0xf bank_mask:0xf
v_add_f32_dpp v10, v10, v10 row_half_mirror row_mask:0xf bank_mask:0xf
s_nop 0
v_add_f32_dpp v8, v8, v8 row_mirror row_mask:0xf bank_mask:0xf
v_add_f32_dpp v10, v10, v10 row_mirror row_mask:0xf bank_mask:0xf
v_mul_f32 v8, 0x3acccccd, v8
v_mul_f32 v10, 0x3acccccd, v10
v_fma_f32 v10, -v8, v8, v10
v_max_f32 v10, 0, v10
v_cvt_pk_bf16_f32 v14, v8, v8
v_and_b32 v14, 0xffff0000, v14
v_cvt_pk_bf16_f32 v9, v10, v10
v_and_b32 v9, 0xffff0000, v9
v_add_f32 v9, 0x3727c5ac, v9
v_cvt_pk_bf16_f32 v9, v9, v9
v_and_b32 v9, 0xffff0000, v9
v_sqrt_f32 v9, v9
s_nop 0
v_cvt_pk_bf16_f32 v9, v9, v9
v_and_b32 v9, 0xffff0000, v9
v_rcp_f32 v12, v9
v_add_u32 v9, s46, v2
v_lshlrev_b32 v9, 2, v9
v_add_u32 v9, 42240, v9
ds_write2_b32 v9, v14, v12 offset1:32
v_mul_f32 v14, v14, v12
v_sub_f32 v14, 0, v14
v_mov_b32 v13, v12
v_mov_b32 v15, v14
v_lshlrev_b32 v60, 16, v16
v_and_b32 v61, 0xffff0000, v16
v_pk_fma_f32 v[60:61], v[60:61], v[12:13], v[14:15]
v_cvt_pk_bf16_f32 v16, v60, v61
v_lshlrev_b32 v62, 16, v17
v_and_b32 v63, 0xffff0000, v17
v_pk_fma_f32 v[62:63], v[62:63], v[12:13], v[14:15]
v_cvt_pk_bf16_f32 v17, v62, v63
v_lshlrev_b32 v64, 16, v18
v_and_b32 v65, 0xffff0000, v18
v_pk_fma_f32 v[64:65], v[64:65], v[12:13], v[14:15]
v_cvt_pk_bf16_f32 v18, v64, v65
v_lshlrev_b32 v66, 16, v19
v_and_b32 v67, 0xffff0000, v19
v_pk_fma_f32 v[66:67], v[66:67], v[12:13], v[14:15]
v_cvt_pk_bf16_f32 v19, v66, v67
v_lshlrev_b32 v68, 16, v20
v_and_b32 v69, 0xffff0000, v20
v_pk_fma_f32 v[68:69], v[68:69], v[12:13], v[14:15]
v_cvt_pk_bf16_f32 v20, v68, v69
v_lshlrev_b32 v70, 16, v21
v_and_b32 v71, 0xffff0000, v21
v_pk_fma_f32 v[70:71], v[70:71], v[12:13], v[14:15]
v_cvt_pk_bf16_f32 v21, v70, v71
v_lshlrev_b32 v72, 16, v22
v_and_b32 v73, 0xffff0000, v22
v_pk_fma_f32 v[72:73], v[72:73], v[12:13], v[14:15]
v_cvt_pk_bf16_f32 v22, v72, v73
v_lshlrev_b32 v74, 16, v23
v_and_b32 v75, 0xffff0000, v23
v_pk_fma_f32 v[74:75], v[74:75], v[12:13], v[14:15]
v_cvt_pk_bf16_f32 v23, v74, v75
v_lshlrev_b32 v60, 16, v24
v_and_b32 v61, 0xffff0000, v24
v_pk_fma_f32 v[60:61], v[60:61], v[12:13], v[14:15]
v_cvt_pk_bf16_f32 v24, v60, v61
v_lshlrev_b32 v62, 16, v25
v_and_b32 v63, 0xffff0000, v25
v_pk_fma_f32 v[62:63], v[62:63], v[12:13], v[14:15]
v_cvt_pk_bf16_f32 v25, v62, v63
v_lshlrev_b32 v64, 16, v26
v_and_b32 v65, 0xffff0000, v26
v_pk_fma_f32 v[64:65], v[64:65], v[12:13], v[14:15]
v_cvt_pk_bf16_f32 v26, v64, v65
v_lshlrev_b32 v66, 16, v27
v_and_b32 v67, 0xffff0000, v27
v_pk_fma_f32 v[66:67], v[66:67], v[12:13], v[14:15]
v_cvt_pk_bf16_f32 v27, v66, v67
v_lshlrev_b32 v68, 16, v28
v_and_b32 v69, 0xffff0000, v28
v_pk_fma_f32 v[68:69], v[68:69], v[12:13], v[14:15]
v_cvt_pk_bf16_f32 v28, v68, v69
v_lshlrev_b32 v70, 16, v29
v_and_b32 v71, 0xffff0000, v29
v_pk_fma_f32 v[70:71], v[70:71], v[12:13], v[14:15]
v_cvt_pk_bf16_f32 v29, v70, v71
v_lshlrev_b32 v72, 16, v30
v_and_b32 v73, 0xffff0000, v30
v_pk_fma_f32 v[72:73], v[72:73], v[12:13], v[14:15]
v_cvt_pk_bf16_f32 v30, v72, v73
v_lshlrev_b32 v74, 16, v31
v_and_b32 v75, 0xffff0000, v31
v_pk_fma_f32 v[74:75], v[74:75], v[12:13], v[14:15]
v_cvt_pk_bf16_f32 v31, v74, v75
v_lshlrev_b32 v60, 16, v32
v_and_b32 v61, 0xffff0000, v32
v_pk_fma_f32 v[60:61], v[60:61], v[12:13], v[14:15]
v_cvt_pk_bf16_f32 v32, v60, v61
v_lshlrev_b32 v62, 16, v33
v_and_b32 v63, 0xffff0000, v33
v_pk_fma_f32 v[62:63], v[62:63], v[12:13], v[14:15]
v_cvt_pk_bf16_f32 v33, v62, v63
v_lshlrev_b32 v64, 16, v34
v_and_b32 v65, 0xffff0000, v34
v_pk_fma_f32 v[64:65], v[64:65], v[12:13], v[14:15]
v_cvt_pk_bf16_f32 v34, v64, v65
v_lshlrev_b32 v66, 16, v35
v_and_b32 v67, 0xffff0000, v35
v_pk_fma_f32 v[66:67], v[66:67], v[12:13], v[14:15]
v_cvt_pk_bf16_f32 v35, v66, v67
v_mov_b32 v8, 0
v_mov_b32 v9, 0
v_mov_b32 v10, 0
v_mov_b32 v11, 0
v_dot2c_f32_bf16 v8, s55, v16
v_dot2c_f32_bf16 v10, v16, v16
v_dot2c_f32_bf16 v9, s55, v17
v_dot2c_f32_bf16 v11, v17, v17
v_dot2c_f32_bf16 v8, s55, v18
v_dot2c_f32_bf16 v10, v18, v18
v_dot2c_f32_bf16 v9, s55, v19
v_dot2c_f32_bf16 v11, v19, v19
v_dot2c_f32_bf16 v8, s55, v20
v_dot2c_f32_bf16 v10, v20, v20
v_dot2c_f32_bf16 v9, s55, v21
v_dot2c_f32_bf16 v11, v21, v21
v_dot2c_f32_bf16 v8, s55, v22
v_dot2c_f32_bf16 v10, v22, v22
v_dot2c_f32_bf16 v9, s55, v23
v_dot2c_f32_bf16 v11, v23, v23
v_dot2c_f32_bf16 v8, s55, v24
v_dot2c_f32_bf16 v10, v24, v24
v_dot2c_f32_bf16 v9, s55, v25
v_dot2c_f32_bf16 v11, v25, v25
v_dot2c_f32_bf16 v8, s55, v26
v_dot2c_f32_bf16 v10, v26, v26
v_dot2c_f32_bf16 v9, s55, v27
v_dot2c_f32_bf16 v11, v27, v27
v_dot2c_f32_bf16 v8, s55, v28
v_dot2c_f32_bf16 v10, v28, v28
v_dot2c_f32_bf16 v9, s55, v29
v_dot2c_f32_bf16 v11, v29, v29
v_dot2c_f32_bf16 v8, s55, v30
v_dot2c_f32_bf16 v10, v30, v30
v_dot2c_f32_bf16 v9, s55, v31
v_dot2c_f32_bf16 v11, v31, v31
v_dot2c_f32_bf16 v8, s55, v32
v_dot2c_f32_bf16 v10, v32, v32
v_dot2c_f32_bf16 v9, s55, v33
v_dot2c_f32_bf16 v11, v33, v33
v_dot2c_f32_bf16 v8, s55, v34
v_dot2c_f32_bf16 v10, v34, v34
v_dot2c_f32_bf16 v9, s55, v35
v_dot2c_f32_bf16 v11, v35, v35
s_nop 1
v_add_f32 v8, v8, v9
v_add_f32 v10, v10, v11
s_nop 0
v_add_f32_dpp v8, v8, v8 quad_perm:[1,0,3,2] row_mask:0xf bank_mask:0xf
v_add_f32_dpp v10, v10, v10 quad_perm:[1,0,3,2] row_mask:0xf bank_mask:0xf
s_nop 0
v_add_f32_dpp v8, v8, v8 quad_perm:[2,3,0,1] row_mask:0xf bank_mask:0xf
v_add_f32_dpp v10, v10, v10 quad_perm:[2,3,0,1] row_mask:0xf bank_mask:0xf
s_nop 0
v_add_f32_dpp v8, v8, v8 row_half_mirror row_mask:0xf bank_mask:0xf
v_add_f32_dpp v10, v10, v10 row_half_mirror row_mask:0xf bank_mask:0xf
s_nop 0
v_add_f32_dpp v8, v8, v8 row_mirror row_mask:0xf bank_mask:0xf
v_add_f32_dpp v10, v10, v10 row_mirror row_mask:0xf bank_mask:0xf
v_mul_f32 v8, 0x3acccccd, v8
v_mul_f32 v10, 0x3acccccd, v10
v_fma_f32 v10, -v8, v8, v10
v_max_f32 v10, 0, v10
v_cvt_pk_bf16_f32 v14, v8, v8
v_and_b32 v14, 0xffff0000, v14
v_cvt_pk_bf16_f32 v9, v10, v10
v_and_b32 v9, 0xffff0000, v9
v_add_f32 v9, 0x3727c5ac, v9
v_cvt_pk_bf16_f32 v9, v9, v9
v_and_b32 v9, 0xffff0000, v9
v_sqrt_f32 v9, v9
s_nop 0
v_cvt_pk_bf16_f32 v9, v9, v9
v_and_b32 v9, 0xffff0000, v9
v_rcp_f32 v12, v9
s_nop 0
v_mul_f32 v14, v14, v12
v_sub_f32 v14, 0, v14
v_mov_b32 v13, v12
v_mov_b32 v15, v14
v_lshlrev_b32 v60, 16, v16
v_and_b32 v61, 0xffff0000, v16
v_pk_fma_f32 v[60:61], v[60:61], v[12:13], v[14:15]
v_cvt_pk_bf16_f32 v16, v60, v61
v_lshlrev_b32 v62, 16, v17
v_and_b32 v63, 0xffff0000, v17
v_pk_fma_f32 v[62:63], v[62:63], v[12:13], v[14:15]
v_cvt_pk_bf16_f32 v17, v62, v63
v_lshlrev_b32 v64, 16, v18
v_and_b32 v65, 0xffff0000, v18
v_pk_fma_f32 v[64:65], v[64:65], v[12:13], v[14:15]
v_cvt_pk_bf16_f32 v18, v64, v65
v_lshlrev_b32 v66, 16, v19
v_and_b32 v67, 0xffff0000, v19
v_pk_fma_f32 v[66:67], v[66:67], v[12:13], v[14:15]
v_cvt_pk_bf16_f32 v19, v66, v67
v_lshlrev_b32 v68, 16, v20
v_and_b32 v69, 0xffff0000, v20
v_pk_fma_f32 v[68:69], v[68:69], v[12:13], v[14:15]
v_cvt_pk_bf16_f32 v20, v68, v69
v_lshlrev_b32 v70, 16, v21
v_and_b32 v71, 0xffff0000, v21
v_pk_fma_f32 v[70:71], v[70:71], v[12:13], v[14:15]
v_cvt_pk_bf16_f32 v21, v70, v71
v_lshlrev_b32 v72, 16, v22
v_and_b32 v73, 0xffff0000, v22
v_pk_fma_f32 v[72:73], v[72:73], v[12:13], v[14:15]
v_cvt_pk_bf16_f32 v22, v72, v73
v_lshlrev_b32 v74, 16, v23
v_and_b32 v75, 0xffff0000, v23
v_pk_fma_f32 v[74:75], v[74:75], v[12:13], v[14:15]
v_cvt_pk_bf16_f32 v23, v74, v75
v_lshlrev_b32 v60, 16, v24
v_and_b32 v61, 0xffff0000, v24
v_pk_fma_f32 v[60:61], v[60:61], v[12:13], v[14:15]
v_cvt_pk_bf16_f32 v24, v60, v61
v_lshlrev_b32 v62, 16, v25
v_and_b32 v63, 0xffff0000, v25
v_pk_fma_f32 v[62:63], v[62:63], v[12:13], v[14:15]
v_cvt_pk_bf16_f32 v25, v62, v63
v_lshlrev_b32 v64, 16, v26
v_and_b32 v65, 0xffff0000, v26
v_pk_fma_f32 v[64:65], v[64:65], v[12:13], v[14:15]
v_cvt_pk_bf16_f32 v26, v64, v65
v_lshlrev_b32 v66, 16, v27
v_and_b32 v67, 0xffff0000, v27
v_pk_fma_f32 v[66:67], v[66:67], v[12:13], v[14:15]
v_cvt_pk_bf16_f32 v27, v66, v67
v_lshlrev_b32 v68, 16, v28
v_and_b32 v69, 0xffff0000, v28
v_pk_fma_f32 v[68:69], v[68:69], v[12:13], v[14:15]
v_cvt_pk_bf16_f32 v28, v68, v69
v_lshlrev_b32 v70, 16, v29
v_and_b32 v71, 0xffff0000, v29
v_pk_fma_f32 v[70:71], v[70:71], v[12:13], v[14:15]
v_cvt_pk_bf16_f32 v29, v70, v71
v_lshlrev_b32 v72, 16, v30
v_and_b32 v73, 0xffff0000, v30
v_pk_fma_f32 v[72:73], v[72:73], v[12:13], v[14:15]
v_cvt_pk_bf16_f32 v30, v72, v73
v_lshlrev_b32 v74, 16, v31
v_and_b32 v75, 0xffff0000, v31
v_pk_fma_f32 v[74:75], v[74:75], v[12:13], v[14:15]
v_cvt_pk_bf16_f32 v31, v74, v75
v_lshlrev_b32 v60, 16, v32
v_and_b32 v61, 0xffff0000, v32
v_pk_fma_f32 v[60:61], v[60:61], v[12:13], v[14:15]
v_cvt_pk_bf16_f32 v32, v60, v61
v_lshlrev_b32 v62, 16, v33
v_and_b32 v63, 0xffff0000, v33
v_pk_fma_f32 v[62:63], v[62:63], v[12:13], v[14:15]
v_cvt_pk_bf16_f32 v33, v62, v63
v_lshlrev_b32 v64, 16, v34
v_and_b32 v65, 0xffff0000, v34
v_pk_fma_f32 v[64:65], v[64:65], v[12:13], v[14:15]
v_cvt_pk_bf16_f32 v34, v64, v65
v_lshlrev_b32 v66, 16, v35
v_and_b32 v67, 0xffff0000, v35
v_pk_fma_f32 v[66:67], v[66:67], v[12:13], v[14:15]
v_cvt_pk_bf16_f32 v35, v66, v67
ds_write_b128 v5, v[16:19] offset:0
ds_write_b128 v5, v[20:23] offset:256
ds_write_b128 v5, v[24:27] offset:512
ds_write_b128 v5, v[28:31] offset:768
ds_write_b128 v5, v[32:35] offset:1024
s_waitcnt lgkmcnt(0)
s_barrier
s_cmp_lg_u32 s42, 3
s_cbranch_scc1 ax_ns
v_lshlrev_b32 v9, 2, v1
ds_read_b32 v8, v9 offset:42240
s_lshl_b32 s51, s43, 8
s_add_u32 s51, s51, 2621440
s_waitcnt lgkmcnt(0)
buffer_store_dword v8, v9, s[24:27], s51 offen sc1
ax_ns:
ds_read_b64_tr_b16 v[16:17], v7 offset:0
ds_read_b64_tr_b16 v[18:19], v7 offset:5248
ds_read_b64_tr_b16 v[20:21], v7 offset:256
ds_read_b64_tr_b16 v[22:23], v7 offset:5504
ds_read_b64_tr_b16 v[24:25], v7 offset:512
ds_read_b64_tr_b16 v[26:27], v7 offset:5760
ds_read_b64_tr_b16 v[28:29], v7 offset:768
ds_read_b64_tr_b16 v[30:31], v7 offset:6016
ds_read_b64_tr_b16 v[32:33], v7 offset:1024
ds_read_b64_tr_b16 v[34:35], v7 offset:6272
s_waitcnt lgkmcnt(8)
buffer_store_dwordx4 v[16:19], v40, s[24:27], s50 offen sc1
s_add_u32 s50, s50, 8192
s_waitcnt lgkmcnt(6)
buffer_store_dwordx4 v[20:23], v40, s[24:27], s50 offen sc1
s_add_u32 s50, s50, 8192
s_waitcnt lgkmcnt(4)
buffer_store_dwordx4 v[24:27], v40, s[24:27], s50 offen sc1
s_add_u32 s50, s50, 8192
s_waitcnt lgkmcnt(2)
buffer_store_dwordx4 v[28:31], v40, s[24:27], s50 offen sc1
s_add_u32 s50, s50, 8192
s_waitcnt lgkmcnt(0)
buffer_store_dwordx4 v[32:35], v40, s[24:27], s50 offen sc1
s_add_u32 s50, s50, 8192
s_cmp_ge_u32 s42, 4
s_cbranch_scc1 laux
s_mov_b32 s56, 0
s_mov_b32 s57, 255
s_mov_b32 s58, 10240
s_cmp_eq_u32 s57, 0
s_cbranch_scc1 ax_p0
s_waitcnt vmcnt(0)
ax_p0:
s_barrier
s_cbranch_scc1 ax_np
s_cmp_lg_u32 s42, 0
s_cbranch_scc1 ax_np
s_add_u32 s8, s14, 15728640
s_addc_u32 s9, s15, 0
s_mov_b32 s10, 65536
s_mov_b32 s11, 0x00020000
v_mul_u32_u24 v2, 256, v1
v_mov_b32 v3, s61
s_mov_b32 exec_lo, s57
s_mov_b32 exec_hi, 0
buffer_atomic_add v3, v2, s[8:11], s56 offen sc1
s_mov_b64 exec, -1
ax_np:
s_mov_b32 s57, 0
s_branch cB
cO:
s_cmp_eq_u32 s57, 0
s_cbranch_scc1 cO_p0
s_waitcnt vmcnt(0)
cO_p0:
s_barrier
s_cbranch_scc1 cO_np
s_cmp_lg_u32 s42, 0
s_cbranch_scc1 cO_np
s_add_u32 s8, s14, 15728640
s_addc_u32 s9, s15, 0
s_mov_b32 s10, 65536
s_mov_b32 s11, 0x00020000
v_mul_u32_u24 v2, 256, v1
v_mov_b32 v3, s61
s_mov_b32 exec_lo, s57
s_mov_b32 exec_hi, 0
buffer_atomic_add v3, v2, s[8:11], s56 offen sc1
s_mov_b64 exec, -1
cO_np:
s_lshl_b32 s45, s40, 2
s_add_u32 s45, s45, s41
s_sub_u32 s45, s45, 12
s_and_b32 s43, s45, 7
s_lshr_b32 s44, s45, 3
s_add_u32 s16, s14, 11534336
s_addc_u32 s17, s15, 0
s_mov_b32 s18, 860160
s_mov_b32 s19, 0x00020000
s_add_u32 s20, s14, 2621440
s_addc_u32 s21, s15, 0
s_mov_b32 s22, 2621440
s_mov_b32 s23, 0x00020000
s_add_u32 s24, s14, 8388608
s_addc_u32 s25, s15, 0
s_mov_b32 s26, 2621440
s_mov_b32 s27, 0x00020000
s_lshl_b32 s60, s43, 2
s_add_u32 s60, s60, s44
s_mul_i32 s60, s60, 256
s_add_u32 s60, s60, 2048
s_mul_i32 s58, s44, 512
s_add_u32 s58, s58, 59392
s_mov_b32 s59, 3
s_mov_b32 s57, 0
v_mov_b32 v34, 0
s_add_u32 s8, s14, 15728640
s_addc_u32 s9, s15, 0
s_mov_b32 s10, 65536
s_mov_b32 s11, 0x00020000
s_cmp_lg_u32 s42, 0
s_cbranch_scc1 cO_ok
s_mov_b32 s63, 0x40000
cO_chk:
v_readfirstlane_b32 s55, v34
s_nop 1
s_cmp_ge_u32 s55, 4096
s_cbranch_scc1 cO_ok
s_sub_u32 s63, s63, 1
s_cbranch_scc1 cO_ok
buffer_load_dword v34, off, s[8:11], s60 sc1
s_waitcnt vmcnt(0)
s_branch cO_chk
cO_ok:
s_barrier
s_lshl_b32 s45, s43, 4
s_lshl_b32 s46, s44, 2
s_add_u32 s45, s45, s46
s_add_u32 s45, s45, s42
s_mul_i32 s45, s45, 20480
v_lshlrev_b32 v7, 4, v1
buffer_load_dwordx4 v[16:19], v7, s[20:23], s45 offen offset:0 sc1
buffer_load_dwordx4 v[20:23], v7, s[20:23], s45 offen offset:1024 sc1
buffer_load_dwordx4 v[24:27], v7, s[20:23], s45 offen offset:2048 sc1
buffer_load_dwordx4 v[28:31], v7, s[20:23], s45 offen offset:3072 sc1
s_add_u32 s45, s45, 4096
buffer_load_dwordx4 v[32:35], v7, s[20:23], s45 offen offset:0 sc1
buffer_load_dwordx4 v[36:39], v7, s[20:23], s45 offen offset:1024 sc1
buffer_load_dwordx4 v[40:43], v7, s[20:23], s45 offen offset:2048 sc1
buffer_load_dwordx4 v[44:47], v7, s[20:23], s45 offen offset:3072 sc1
s_add_u32 s45, s45, 4096
buffer_load_dwordx4 v[48:51], v7, s[20:23], s45 offen offset:0 sc1
buffer_load_dwordx4 v[52:55], v7, s[20:23], s45 offen offset:1024 sc1
buffer_load_dwordx4 v[56:59], v7, s[20:23], s45 offen offset:2048 sc1
buffer_load_dwordx4 v[60:63], v7, s[20:23], s45 offen offset:3072 sc1
s_add_u32 s45, s45, 4096
buffer_load_dwordx4 v[64:67], v7, s[20:23], s45 offen offset:0 sc1
buffer_load_dwordx4 v[68:71], v7, s[20:23], s45 offen offset:1024 sc1
buffer_load_dwordx4 v[72:75], v7, s[20:23], s45 offen offset:2048 sc1
buffer_load_dwordx4 v[76:79], v7, s[20:23], s45 offen offset:3072 sc1
s_add_u32 s45, s45, 4096
buffer_load_dwordx4 v[80:83], v7, s[20:23], s45 offen offset:0 sc1
buffer_load_dwordx4 v[84:87], v7, s[20:23], s45 offen offset:1024 sc1
buffer_load_dwordx4 v[88:91], v7, s[20:23], s45 offen offset:2048 sc1
buffer_load_dwordx4 v[92:95], v7, s[20:23], s45 offen offset:3072 sc1
s_add_u32 s45, s45, 4096
v_and_b32 v6, 31, v1
v_lshrrev_b32 v8, 5, v1
v_lshlrev_b32 v9, 3, v8
v_mov_b32 v5, 114176
v_add_u32 v2, 0, v6
v_mul_u32_u24 v10, 40, v2
v_add_u32 v10, 110592, v10
v_mul_u32_u24 v3, 3277, v2
v_lshrrev_b32 v3, 16, v3
v_mul_u32_u24 v3, 20, v3
v_sub_u32 v13, v9, v3
v_add_u32 v2, 32, v6
v_mul_u32_u24 v11, 40, v2
v_add_u32 v11, 110592, v11
v_mul_u32_u24 v3, 3277, v2
v_lshrrev_b32 v3, 16, v3
v_mul_u32_u24 v3, 20, v3
v_sub_u32 v14, v9, v3
v_add_u32 v2, 64, v6
v_mul_u32_u24 v12, 40, v2
v_add_u32 v12, 110592, v12
v_mul_u32_u24 v3, 3277, v2
v_lshrrev_b32 v3, 16, v3
v_mul_u32_u24 v3, 20, v3
v_sub_u32 v15, v9, v3
v_and_b32 v2, 3, v1
v_bfe_u32 v3, v1, 3, 2
v_lshl_add_u32 v2, v3, 2, v2
v_and_b32 v3, 4, v1
v_lshl_add_u32 v2, v2, 3, v3
v_mul_u32_u24 v3, 3277, v2
v_lshrrev_b32 v3, 16, v3
v_mul_u32_u24 v3, 20, v3
v_sub_u32 v252, v9, v3
v_add_u32 v2, 0, v13
v_lshl_add_u32 v3, v2, 1, v10
v_cmp_gt_u32 vcc, 20, v2
s_nop 1
v_cndmask_b32 v224, v5, v3, vcc
v_add_u32 v2, 4, v13
v_lshl_add_u32 v3, v2, 1, v10
v_cmp_gt_u32 vcc, 20, v2
s_nop 1
v_cndmask_b32 v225, v5, v3, vcc
v_add_u32 v2, 16, v13
v_lshl_add_u32 v3, v2, 1, v10
v_cmp_gt_u32 vcc, 20, v2
s_nop 1
v_cndmask_b32 v226, v5, v3, vcc
v_add_u32 v2, 20, v13
v_lshl_add_u32 v3, v2, 1, v10
v_cmp_gt_u32 vcc, 20, v2
s_nop 1
v_cndmask_b32 v227, v5, v3, vcc
v_add_u32 v2, 32, v13
v_lshl_add_u32 v3, v2, 1, v10
v_cmp_gt_u32 vcc, 20, v2
s_nop 1
v_cndmask_b32 v228, v5, v3, vcc
v_add_u32 v2, 36, v13
v_lshl_add_u32 v3, v2, 1, v10
v_cmp_gt_u32 vcc, 20, v2
s_nop 1
v_cndmask_b32 v229, v5, v3, vcc
v_add_u32 v2, 16, v14
v_lshl_add_u32 v3, v2, 1, v11
v_cmp_gt_u32 vcc, 20, v2
s_nop 1
v_cndmask_b32 v230, v5, v3, vcc
v_add_u32 v2, 20, v14
v_lshl_add_u32 v3, v2, 1, v11
v_cmp_gt_u32 vcc, 20, v2
s_nop 1
v_cndmask_b32 v231, v5, v3, vcc
v_add_u32 v2, 32, v14
v_lshl_add_u32 v3, v2, 1, v11
v_cmp_gt_u32 vcc, 20, v2
s_nop 1
v_cndmask_b32 v232, v5, v3, vcc
v_add_u32 v2, 36, v14
v_lshl_add_u32 v3, v2, 1, v11
v_cmp_gt_u32 vcc, 20, v2
s_nop 1
v_cndmask_b32 v233, v5, v3, vcc
v_add_u32 v2, 48, v14
v_lshl_add_u32 v3, v2, 1, v11
v_cmp_gt_u32 vcc, 20, v2
s_nop 1
v_cndmask_b32 v234, v5, v3, vcc
v_add_u32 v2, 52, v14
v_lshl_add_u32 v3, v2, 1, v11
v_cmp_gt_u32 vcc, 20, v2
s_nop 1
v_cndmask_b32 v235, v5, v3, vcc
v_add_u32 v2, 64, v14
v_lshl_add_u32 v3, v2, 1, v11
v_cmp_gt_u32 vcc, 20, v2
s_nop 1
v_cndmask_b32 v236, v5, v3, vcc
v_add_u32 v2, 68, v14
v_lshl_add_u32 v3, v2, 1, v11
v_cmp_gt_u32 vcc, 20, v2
s_nop 1
v_cndmask_b32 v237, v5, v3, vcc
v_add_u32 v2, 48, v15
v_lshl_add_u32 v3, v2, 1, v12
v_cmp_gt_u32 vcc, 20, v2
s_nop 1
v_cndmask_b32 v238, v5, v3, vcc
v_add_u32 v2, 52, v15
v_lshl_add_u32 v3, v2, 1, v12
v_cmp_gt_u32 vcc, 20, v2
s_nop 1
v_cndmask_b32 v239, v5, v3, vcc
v_add_u32 v2, 64, v15
v_lshl_add_u32 v3, v2, 1, v12
v_cmp_gt_u32 vcc, 20, v2
s_nop 1
v_cndmask_b32 v240, v5, v3, vcc
v_add_u32 v2, 68, v15
v_lshl_add_u32 v3, v2, 1, v12
v_cmp_gt_u32 vcc, 20, v2
s_nop 1
v_cndmask_b32 v241, v5, v3, vcc
v_add_u32 v2, 0, v252
v_lshlrev_b32 v3, 1, v9
v_add_u32 v3, 113792, v3
v_cmp_gt_u32 vcc, 20, v2
s_nop 1
v_cndmask_b32 v242, v5, v3, vcc
v_add_u32 v2, 4, v252
v_lshlrev_b32 v3, 1, v9
v_add_u32 v3, 113800, v3
v_cmp_gt_u32 vcc, 20, v2
s_nop 1
v_cndmask_b32 v243, v5, v3, vcc
v_add_u32 v2, 16, v252
v_lshlrev_b32 v3, 1, v9
v_add_u32 v3, 113824, v3
v_cmp_gt_u32 vcc, 20, v2
s_nop 1
v_cndmask_b32 v244, v5, v3, vcc
v_add_u32 v2, 20, v252
v_lshlrev_b32 v3, 1, v9
v_add_u32 v3, 113832, v3
v_cmp_gt_u32 vcc, 20, v2
s_nop 1
v_cndmask_b32 v245, v5, v3, vcc
v_add_u32 v2, 32, v252
v_lshlrev_b32 v3, 1, v9
v_add_u32 v3, 113856, v3
v_cmp_gt_u32 vcc, 20, v2
s_nop 1
v_cndmask_b32 v246, v5, v3, vcc
v_add_u32 v2, 36, v252
v_lshlrev_b32 v3, 1, v9
v_add_u32 v3, 113864, v3
v_cmp_gt_u32 vcc, 20, v2
s_nop 1
v_cndmask_b32 v247, v5, v3, vcc
v_add_u32 v2, 48, v252
v_lshlrev_b32 v3, 1, v9
v_add_u32 v3, 113888, v3
v_cmp_gt_u32 vcc, 20, v2
s_nop 1
v_cndmask_b32 v248, v5, v3, vcc
v_add_u32 v2, 52, v252
v_lshlrev_b32 v3, 1, v9
v_add_u32 v3, 113896, v3
v_cmp_gt_u32 vcc, 20, v2
s_nop 1
v_cndmask_b32 v249, v5, v3, vcc
v_add_u32 v2, 64, v252
v_lshlrev_b32 v3, 1, v9
v_add_u32 v3, 113920, v3
v_cmp_gt_u32 vcc, 20, v2
s_nop 1
v_cndmask_b32 v250, v5, v3, vcc
v_add_u32 v2, 68, v252
v_lshlrev_b32 v3, 1, v9
v_add_u32 v3, 113928, v3
v_cmp_gt_u32 vcc, 20, v2
s_nop 1
v_cndmask_b32 v251, v5, v3, vcc
v_mov_b32 v96, 0
s_cmp_lg_u32 s42, 0
s_cbranch_scc1 cO2_ok
s_mov_b32 s63, 0x40000
cO2_chk:
v_readfirstlane_b32 s55, v96
s_nop 1
s_cmp_ge_u32 s55, 4112
s_cbranch_scc1 cO2_ok
s_sub_u32 s63, s63, 1
s_cbranch_scc1 cO2_ok
buffer_load_dword v96, off, s[8:11], s60 sc1
s_waitcnt vmcnt(0)
s_branch cO2_chk
cO2_ok:
s_barrier
s_mul_i32 s45, s43, 6720
v_lshlrev_b32 v2, 4, v0
v_add_u32 v3, s45, v2
v_add_u32 v4, 4096, v3
v_mov_b32 v5, 1073741824
v_cmp_gt_u32 vcc, 164, v0
s_nop 1
v_cndmask_b32 v4, v5, v4, vcc
s_mov_b32 s46, 0
buffer_load_dwordx4 v[96:99], v3, s[16:19], s46 offen sc1
buffer_load_dwordx4 v[100:103], v4, s[16:19], s46 offen sc1
s_add_u32 s46, s46, 53760
buffer_load_dwordx4 v[104:107], v3, s[16:19], s46 offen sc1
buffer_load_dwordx4 v[108:111], v4, s[16:19], s46 offen sc1
s_add_u32 s46, s46, 53760
buffer_load_dwordx4 v[112:115], v3, s[16:19], s46 offen sc1
buffer_load_dwordx4 v[116:119], v4, s[16:19], s46 offen sc1
s_add_u32 s46, s46, 53760
buffer_load_dwordx4 v[120:123], v3, s[16:19], s46 offen sc1
buffer_load_dwordx4 v[124:127], v4, s[16:19], s46 offen sc1
s_add_u32 s46, s46, 53760
buffer_load_dwordx4 v[128:131], v3, s[16:19], s46 offen sc1
buffer_load_dwordx4 v[132:135], v4, s[16:19], s46 offen sc1
s_add_u32 s46, s46, 53760
buffer_load_dwordx4 v[136:139], v3, s[16:19], s46 offen sc1
buffer_load_dwordx4 v[140:143], v4, s[16:19], s46 offen sc1
s_add_u32 s46, s46, 53760
buffer_load_dwordx4 v[144:147], v3, s[16:19], s46 offen sc1
buffer_load_dwordx4 v[148:151], v4, s[16:19], s46 offen sc1
s_add_u32 s46, s46, 53760
buffer_load_dwordx4 v[152:155], v3, s[16:19], s46 offen sc1
buffer_load_dwordx4 v[156:159], v4, s[16:19], s46 offen sc1
s_add_u32 s46, s46, 53760
buffer_load_dwordx4 v[160:163], v3, s[16:19], s46 offen sc1
buffer_load_dwordx4 v[164:167], v4, s[16:19], s46 offen sc1
s_add_u32 s46, s46, 53760
buffer_load_dwordx4 v[168:171], v3, s[16:19], s46 offen sc1
buffer_load_dwordx4 v[172:175], v4, s[16:19], s46 offen sc1
s_add_u32 s46, s46, 53760
buffer_load_dwordx4 v[176:179], v3, s[16:19], s46 offen sc1
buffer_load_dwordx4 v[180:183], v4, s[16:19], s46 offen sc1
s_add_u32 s46, s46, 53760
buffer_load_dwordx4 v[184:187], v3, s[16:19], s46 offen sc1
buffer_load_dwordx4 v[188:191], v4, s[16:19], s46 offen sc1
s_add_u32 s46, s46, 53760
buffer_load_dwordx4 v[192:195], v3, s[16:19], s46 offen sc1
buffer_load_dwordx4 v[196:199], v4, s[16:19], s46 offen sc1
s_add_u32 s46, s46, 53760
buffer_load_dwordx4 v[200:203], v3, s[16:19], s46 offen sc1
buffer_load_dwordx4 v[204:207], v4, s[16:19], s46 offen sc1
s_add_u32 s46, s46, 53760
buffer_load_dwordx4 v[208:211], v3, s[16:19], s46 offen sc1
buffer_load_dwordx4 v[212:215], v4, s[16:19], s46 offen sc1
s_add_u32 s46, s46, 53760
buffer_load_dwordx4 v[216:219], v3, s[16:19], s46 offen sc1
buffer_load_dwordx4 v[220:223], v4, s[16:19], s46 offen sc1
s_add_u32 s46, s46, 53760
s_waitcnt vmcnt(28)
v_pk_add_f32 v[96:97], v[96:97], v[104:105]
v_pk_add_f32 v[98:99], v[98:99], v[106:107]
v_pk_add_f32 v[100:101], v[100:101], v[108:109]
v_pk_add_f32 v[102:103], v[102:103], v[110:111]
s_waitcnt vmcnt(26)
v_pk_add_f32 v[96:97], v[96:97], v[112:113]
v_pk_add_f32 v[98:99], v[98:99], v[114:115]
v_pk_add_f32 v[100:101], v[100:101], v[116:117]
v_pk_add_f32 v[102:103], v[102:103], v[118:119]
s_waitcnt vmcnt(24)
v_pk_add_f32 v[96:97], v[96:97], v[120:121]
v_pk_add_f32 v[98:99], v[98:99], v[122:123]
v_pk_add_f32 v[100:101], v[100:101], v[124:125]
v_pk_add_f32 v[102:103], v[102:103], v[126:127]
s_waitcnt vmcnt(22)
v_pk_add_f32 v[96:97], v[96:97], v[128:129]
v_pk_add_f32 v[98:99], v[98:99], v[130:131]
v_pk_add_f32 v[100:101], v[100:101], v[132:133]
v_pk_add_f32 v[102:103], v[102:103], v[134:135]
s_waitcnt vmcnt(20)
v_pk_add_f32 v[96:97], v[96:97], v[136:137]
v_pk_add_f32 v[98:99], v[98:99], v[138:139]
v_pk_add_f32 v[100:101], v[100:101], v[140:141]
v_pk_add_f32 v[102:103], v[102:103], v[142:143]
s_waitcnt vmcnt(18)
v_pk_add_f32 v[96:97], v[96:97], v[144:145]
v_pk_add_f32 v[98:99], v[98:99], v[146:147]
v_pk_add_f32 v[100:101], v[100:101], v[148:149]
v_pk_add_f32 v[102:103], v[102:103], v[150:151]
s_waitcnt vmcnt(16)
v_pk_add_f32 v[96:97], v[96:97], v[152:153]
v_pk_add_f32 v[98:99], v[98:99], v[154:155]
v_pk_add_f32 v[100:101], v[100:101], v[156:157]
v_pk_add_f32 v[102:103], v[102:103], v[158:159]
s_waitcnt vmcnt(14)
v_pk_add_f32 v[96:97], v[96:97], v[160:161]
v_pk_add_f32 v[98:99], v[98:99], v[162:163]
v_pk_add_f32 v[100:101], v[100:101], v[164:165]
v_pk_add_f32 v[102:103], v[102:103], v[166:167]
s_waitcnt vmcnt(12)
v_pk_add_f32 v[96:97], v[96:97], v[168:169]
v_pk_add_f32 v[98:99], v[98:99], v[170:171]
v_pk_add_f32 v[100:101], v[100:101], v[172:173]
v_pk_add_f32 v[102:103], v[102:103], v[174:175]
s_waitcnt vmcnt(10)
v_pk_add_f32 v[96:97], v[96:97], v[176:177]
v_pk_add_f32 v[98:99], v[98:99], v[178:179]
v_pk_add_f32 v[100:101], v[100:101], v[180:181]
v_pk_add_f32 v[102:103], v[102:103], v[182:183]
s_waitcnt vmcnt(8)
v_pk_add_f32 v[96:97], v[96:97], v[184:185]
v_pk_add_f32 v[98:99], v[98:99], v[186:187]
v_pk_add_f32 v[100:101], v[100:101], v[188:189]
v_pk_add_f32 v[102:103], v[102:103], v[190:191]
s_waitcnt vmcnt(6)
v_pk_add_f32 v[96:97], v[96:97], v[192:193]
v_pk_add_f32 v[98:99], v[98:99], v[194:195]
v_pk_add_f32 v[100:101], v[100:101], v[196:197]
v_pk_add_f32 v[102:103], v[102:103], v[198:199]
s_waitcnt vmcnt(4)
v_pk_add_f32 v[96:97], v[96:97], v[200:201]
v_pk_add_f32 v[98:99], v[98:99], v[202:203]
v_pk_add_f32 v[100:101], v[100:101], v[204:205]
v_pk_add_f32 v[102:103], v[102:103], v[206:207]
s_waitcnt vmcnt(2)
v_pk_add_f32 v[96:97], v[96:97], v[208:209]
v_pk_add_f32 v[98:99], v[98:99], v[210:211]
v_pk_add_f32 v[100:101], v[100:101], v[212:213]
v_pk_add_f32 v[102:103], v[102:103], v[214:215]
s_waitcnt vmcnt(0)
v_pk_add_f32 v[96:97], v[96:97], v[216:217]
v_pk_add_f32 v[98:99], v[98:99], v[218:219]
v_pk_add_f32 v[100:101], v[100:101], v[220:221]
v_pk_add_f32 v[102:103], v[102:103], v[222:223]
v_cvt_pk_bf16_f32 v104, v96, v97
v_cvt_pk_bf16_f32 v105, v98, v99
v_cvt_pk_bf16_f32 v106, v100, v101
v_cvt_pk_bf16_f32 v107, v102, v103
v_lshlrev_b32 v2, 3, v0
v_add_u32 v2, 110592, v2
ds_write_b64 v2, v[104:105]
ds_write_b64 v2, v[106:107] offset:2048
s_waitcnt lgkmcnt(0)
s_barrier
ds_read_b64 v[96:97], v224
ds_read_b64 v[98:99], v225
ds_read_b64 v[100:101], v226
ds_read_b64 v[102:103], v227
ds_read_b64 v[104:105], v228
ds_read_b64 v[106:107], v229
ds_read_b64 v[108:109], v230
ds_read_b64 v[110:111], v231
ds_read_b64 v[112:113], v232
ds_read_b64 v[114:115], v233
ds_read_b64 v[116:117], v234
ds_read_b64 v[118:119], v235
ds_read_b64 v[120:121], v236
ds_read_b64 v[122:123], v237
ds_read_b64 v[124:125], v238
ds_read_b64 v[126:127], v239
ds_read_b64 v[128:129], v240
ds_read_b64 v[130:131], v241
ds_read_b64 v[132:133], v242
ds_read_b64 v[134:135], v243
ds_read_b64 v[136:137], v244
ds_read_b64 v[138:139], v245
ds_read_b64 v[140:141], v246
ds_read_b64 v[142:143], v247
ds_read_b64 v[144:145], v248
ds_read_b64 v[146:147], v249
ds_read_b64 v[148:149], v250
ds_read_b64 v[150:151], v251
v_mov_b32 v152, 0x358637bd
v_mov_b32 v153, 0x358637bd
v_mov_b32 v154, 0x358637bd
v_mov_b32 v155, 0x358637bd
v_mov_b32 v156, 0x358637bd
v_mov_b32 v157, 0x358637bd
v_mov_b32 v158, 0x358637bd
v_mov_b32 v159, 0x358637bd
v_mov_b32 v160, 0x358637bd
v_mov_b32 v161, 0x358637bd
v_mov_b32 v162, 0x358637bd
v_mov_b32 v163, 0x358637bd
v_mov_b32 v164, 0x358637bd
v_mov_b32 v165, 0x358637bd
v_mov_b32 v166, 0x358637bd
v_mov_b32 v167, 0x358637bd
s_mul_i32 s45, s42, 11264
s_add_u32 s45, s45, 114688
v_mul_u32_u24 v2, 176, v6
v_add_u32 v2, s45, v2
v_add_u32 v2, v2, v9
v_lshrrev_b32 v3, 4, v1
v_bfe_u32 v4, v1, 1, 1
v_lshl_add_u32 v3, v3, 1, v4
v_bfe_u32 v4, v1, 2, 2
v_lshl_add_u32 v5, v3, 3, v4
v_mul_u32_u24 v5, 176, v5
v_and_b32 v4, 1, v1
v_lshl_add_u32 v5, v4, 3, v5
v_add_u32 v5, s45, v5
s_mul_i32 s46, s43, 80
v_and_b32 v7, 7, v1
v_add_u32 v7, s46, v7
v_lshlrev_b32 v7, 12, v7
v_lshrrev_b32 v3, 3, v1
v_lshl_add_u32 v7, v3, 4, v7
s_lshl_b32 s46, s44, 10
s_lshl_b32 s47, s42, 8
s_add_u32 s46, s46, s47
v_add_u32 v7, s46, v7
s_waitcnt vmcnt(0) lgkmcnt(0)
v_mfma_f32_32x32x16_bf16 v[216:231], v[132:135], v[16:19], v[152:167]
v_mfma_f32_32x32x16_bf16 v[216:231], v[136:139], v[20:23], v[216:231]
v_mfma_f32_32x32x16_bf16 v[216:231], v[140:143], v[24:27], v[216:231]
v_mfma_f32_32x32x16_bf16 v[216:231], v[144:147], v[28:31], v[216:231]
v_mfma_f32_32x32x16_bf16 v[216:231], v[148:151], v[32:35], v[216:231]
v_mfma_f32_32x32x16_bf16 v[168:183], v[96:99], v[16:19], 0
v_mfma_f32_32x32x16_bf16 v[168:183], v[100:103], v[20:23], v[168:183]
s_nop 9
v_rcp_f32 v232, v216
v_rcp_f32 v233, v217
v_rcp_f32 v234, v218
v_rcp_f32 v235, v219
v_mfma_f32_32x32x16_bf16 v[168:183], v[104:107], v[24:27], v[168:183]
v_rcp_f32 v236, v220
v_rcp_f32 v237, v221
v_rcp_f32 v238, v222
v_rcp_f32 v239, v223
v_mfma_f32_32x32x16_bf16 v[184:199], v[108:111], v[20:23], 0
v_rcp_f32 v240, v224
v_rcp_f32 v241, v225
v_mfma_f32_32x32x16_bf16 v[184:199], v[112:115], v[24:27], v[184:199]
s_nop 3
v_mul_f32 v168, v168, v232
v_mul_f32 v169, v169, v232
v_mul_f32 v170, v170, v232
v_mul_f32 v171, v171, v232
v_cvt_pk_bf16_f32 v168, v168, v169
v_cvt_pk_bf16_f32 v169, v170, v171
v_mfma_f32_32x32x16_bf16 v[184:199], v[116:119], v[28:31], v[184:199]
ds_write_b64 v2, v[168:169] offset:0
v_mul_f32 v172, v172, v233
v_mul_f32 v173, v173, v233
v_mul_f32 v174, v174, v233
v_mul_f32 v175, v175, v233
v_cvt_pk_bf16_f32 v172, v172, v173
v_mfma_f32_32x32x16_bf16 v[184:199], v[120:123], v[32:35], v[184:199]
v_cvt_pk_bf16_f32 v173, v174, v175
ds_write_b64 v2, v[172:173] offset:16
v_mul_f32 v176, v176, v234
v_mul_f32 v177, v177, v234
v_mul_f32 v178, v178, v234
v_mul_f32 v179, v179, v234
v_mfma_f32_32x32x16_bf16 v[200:215], v[124:127], v[28:31], 0
v_cvt_pk_bf16_f32 v176, v176, v177
v_cvt_pk_bf16_f32 v177, v178, v179
ds_write_b64 v2, v[176:177] offset:32
v_mul_f32 v180, v180, v235
v_mul_f32 v181, v181, v235
v_mul_f32 v182, v182, v235
v_mfma_f32_32x32x16_bf16 v[200:215], v[128:131], v[32:35], v[200:215]
v_mul_f32 v183, v183, v235
v_cvt_pk_bf16_f32 v180, v180, v181
v_cvt_pk_bf16_f32 v181, v182, v183
ds_write_b64 v2, v[180:181] offset:48
v_mfma_f32_32x32x16_bf16 v[216:231], v[132:135], v[36:39], v[152:167]
v_mul_f32 v184, v184, v236
v_mul_f32 v185, v185, v236
v_mul_f32 v186, v186, v236
v_mul_f32 v187, v187, v236
v_cvt_pk_bf16_f32 v184, v184, v185
v_cvt_pk_bf16_f32 v185, v186, v187
ds_write_b64 v2, v[184:185] offset:64
v_mul_f32 v188, v188, v237
v_mul_f32 v189, v189, v237
v_mfma_f32_32x32x16_bf16 v[216:231], v[136:139], v[40:43], v[216:231]
v_mul_f32 v190, v190, v237
v_mul_f32 v191, v191, v237
v_cvt_pk_bf16_f32 v188, v188, v189
v_cvt_pk_bf16_f32 v189, v190, v191
ds_write_b64 v2, v[188:189] offset:80
v_mul_f32 v192, v192, v238
v_mul_f32 v193, v193, v238
v_mul_f32 v194, v194, v238
v_mul_f32 v195, v195, v238
v_mfma_f32_32x32x16_bf16 v[216:231], v[140:143], v[44:47], v[216:231]
v_cvt_pk_bf16_f32 v192, v192, v193
v_cvt_pk_bf16_f32 v193, v194, v195
ds_write_b64 v2, v[192:193] offset:96
v_mul_f32 v196, v196, v239
v_mul_f32 v197, v197, v239
v_mul_f32 v198, v198, v239
v_mul_f32 v199, v199, v239
v_cvt_pk_bf16_f32 v196, v196, v197
v_cvt_pk_bf16_f32 v197, v198, v199
v_mfma_f32_32x32x16_bf16 v[216:231], v[144:147], v[48:51], v[216:231]
ds_write_b64 v2, v[196:197] offset:112
v_mul_f32 v200, v200, v240
v_mul_f32 v201, v201, v240
v_mul_f32 v202, v202, v240
v_mul_f32 v203, v203, v240
v_cvt_pk_bf16_f32 v200, v200, v201
v_cvt_pk_bf16_f32 v201, v202, v203
ds_write_b64 v2, v[200:201] offset:128
v_mul_f32 v204, v204, v241
v_mfma_f32_32x32x16_bf16 v[216:231], v[148:151], v[52:55], v[216:231]
v_mul_f32 v205, v205, v241
v_mul_f32 v206, v206, v241
v_mul_f32 v207, v207, v241
v_cvt_pk_bf16_f32 v204, v204, v205
v_cvt_pk_bf16_f32 v205, v206, v207
ds_write_b64 v2, v[204:205] offset:144
v_mfma_f32_32x32x16_bf16 v[168:183], v[96:99], v[36:39], 0
v_mfma_f32_32x32x16_bf16 v[168:183], v[100:103], v[40:43], v[168:183]
s_nop 3
v_rcp_f32 v242, v216
v_rcp_f32 v243, v217
v_rcp_f32 v244, v218
v_rcp_f32 v245, v219
v_mfma_f32_32x32x16_bf16 v[168:183], v[104:107], v[44:47], v[168:183]
v_rcp_f32 v246, v220
v_rcp_f32 v247, v221
v_rcp_f32 v248, v222
v_rcp_f32 v249, v223
v_mfma_f32_32x32x16_bf16 v[184:199], v[108:111], v[40:43], 0
v_rcp_f32 v250, v224
v_rcp_f32 v251, v225
v_mfma_f32_32x32x16_bf16 v[184:199], v[112:115], v[44:47], v[184:199]
s_nop 3
v_mul_f32 v168, v168, v242
v_mul_f32 v169, v169, v242
v_mul_f32 v170, v170, v242
v_mul_f32 v171, v171, v242
v_cvt_pk_bf16_f32 v168, v168, v169
v_cvt_pk_bf16_f32 v169, v170, v171
v_mfma_f32_32x32x16_bf16 v[184:199], v[116:119], v[48:51], v[184:199]
ds_write_b64 v2, v[168:169] offset:5632
v_mul_f32 v172, v172, v243
v_mul_f32 v173, v173, v243
v_mul_f32 v174, v174, v243
v_mul_f32 v175, v175, v243
v_cvt_pk_bf16_f32 v172, v172, v173
v_mfma_f32_32x32x16_bf16 v[184:199], v[120:123], v[52:55], v[184:199]
v_cvt_pk_bf16_f32 v173, v174, v175
ds_write_b64 v2, v[172:173] offset:5648
v_mul_f32 v176, v176, v244
v_mul_f32 v177, v177, v244
v_mul_f32 v178, v178, v244
v_mul_f32 v179, v179, v244
v_mfma_f32_32x32x16_bf16 v[200:215], v[124:127], v[48:51], 0
v_cvt_pk_bf16_f32 v176, v176, v177
v_cvt_pk_bf16_f32 v177, v178, v179
ds_write_b64 v2, v[176:177] offset:5664
v_mul_f32 v180, v180, v245
v_mul_f32 v181, v181, v245
v_mul_f32 v182, v182, v245
v_mfma_f32_32x32x16_bf16 v[200:215], v[128:131], v[52:55], v[200:215]
v_mul_f32 v183, v183, v245
v_cvt_pk_bf16_f32 v180, v180, v181
v_cvt_pk_bf16_f32 v181, v182, v183
ds_write_b64 v2, v[180:181] offset:5680
v_mfma_f32_32x32x16_bf16 v[216:231], v[132:135], v[56:59], v[152:167]
v_mul_f32 v184, v184, v246
v_mul_f32 v185, v185, v246
v_mul_f32 v186, v186, v246
v_mul_f32 v187, v187, v246
v_cvt_pk_bf16_f32 v184, v184, v185
v_cvt_pk_bf16_f32 v185, v186, v187
ds_write_b64 v2, v[184:185] offset:5696
v_mul_f32 v188, v188, v247
v_mul_f32 v189, v189, v247
v_mfma_f32_32x32x16_bf16 v[216:231], v[136:139], v[60:63], v[216:231]
v_mul_f32 v190, v190, v247
v_mul_f32 v191, v191, v247
v_cvt_pk_bf16_f32 v188, v188, v189
v_cvt_pk_bf16_f32 v189, v190, v191
ds_write_b64 v2, v[188:189] offset:5712
v_mul_f32 v192, v192, v248
v_mul_f32 v193, v193, v248
v_mul_f32 v194, v194, v248
v_mul_f32 v195, v195, v248
v_mfma_f32_32x32x16_bf16 v[216:231], v[140:143], v[64:67], v[216:231]
v_cvt_pk_bf16_f32 v192, v192, v193
v_cvt_pk_bf16_f32 v193, v194, v195
ds_write_b64 v2, v[192:193] offset:5728
v_mul_f32 v196, v196, v249
v_mul_f32 v197, v197, v249
v_mul_f32 v198, v198, v249
v_mul_f32 v199, v199, v249
v_cvt_pk_bf16_f32 v196, v196, v197
v_cvt_pk_bf16_f32 v197, v198, v199
v_mfma_f32_32x32x16_bf16 v[216:231], v[144:147], v[68:71], v[216:231]
ds_write_b64 v2, v[196:197] offset:5744
v_mul_f32 v200, v200, v250
v_mul_f32 v201, v201, v250
v_mul_f32 v202, v202, v250
v_mul_f32 v203, v203, v250
v_cvt_pk_bf16_f32 v200, v200, v201
v_cvt_pk_bf16_f32 v201, v202, v203
ds_write_b64 v2, v[200:201] offset:5760
v_mul_f32 v204, v204, v251
v_mfma_f32_32x32x16_bf16 v[216:231], v[148:151], v[72:75], v[216:231]
v_mul_f32 v205, v205, v251
v_mul_f32 v206, v206, v251
v_mul_f32 v207, v207, v251
v_cvt_pk_bf16_f32 v204, v204, v205
v_cvt_pk_bf16_f32 v205, v206, v207
ds_write_b64 v2, v[204:205] offset:5776
v_mfma_f32_32x32x16_bf16 v[168:183], v[96:99], v[56:59], 0
s_waitcnt lgkmcnt(0)
ds_read_b64_tr_b16 v[16:17], v5 offset:0
ds_read_b64_tr_b16 v[18:19], v5 offset:704
ds_read_b64_tr_b16 v[20:21], v5 offset:16
ds_read_b64_tr_b16 v[22:23], v5 offset:720
ds_read_b64_tr_b16 v[24:25], v5 offset:32
ds_read_b64_tr_b16 v[26:27], v5 offset:736
ds_read_b64_tr_b16 v[28:29], v5 offset:48
v_mfma_f32_32x32x16_bf16 v[168:183], v[100:103], v[60:63], v[168:183]
ds_read_b64_tr_b16 v[30:31], v5 offset:752
ds_read_b64_tr_b16 v[32:33], v5 offset:64
ds_read_b64_tr_b16 v[34:35], v5 offset:768
ds_read_b64_tr_b16 v[36:37], v5 offset:80
ds_read_b64_tr_b16 v[38:39], v5 offset:784
ds_read_b64_tr_b16 v[40:41], v5 offset:96
ds_read_b64_tr_b16 v[42:43], v5 offset:800
ds_read_b64_tr_b16 v[44:45], v5 offset:112
v_mfma_f32_32x32x16_bf16 v[168:183], v[104:107], v[64:67], v[168:183]
ds_read_b64_tr_b16 v[46:47], v5 offset:816
ds_read_b64_tr_b16 v[48:49], v5 offset:128
ds_read_b64_tr_b16 v[50:51], v5 offset:832
ds_read_b64_tr_b16 v[52:53], v5 offset:144
ds_read_b64_tr_b16 v[54:55], v5 offset:848
v_rcp_f32 v232, v216
v_rcp_f32 v233, v217
v_rcp_f32 v234, v218
v_mfma_f32_32x32x16_bf16 v[184:199], v[108:111], v[60:63], 0
v_rcp_f32 v235, v219
v_rcp_f32 v236, v220
v_rcp_f32 v237, v221
v_rcp_f32 v238, v222
v_rcp_f32 v239, v223
v_rcp_f32 v240, v224
v_rcp_f32 v241, v225
s_waitcnt lgkmcnt(0)
v_mfma_f32_32x32x16_bf16 v[184:199], v[112:115], v[64:67], v[184:199]
v_mul_f32 v168, v168, v232
v_mul_f32 v169, v169, v232
v_mul_f32 v170, v170, v232
v_mul_f32 v171, v171, v232
v_cvt_pk_bf16_f32 v168, v168, v169
v_cvt_pk_bf16_f32 v169, v170, v171
ds_write_b64 v2, v[168:169] offset:0
v_mul_f32 v172, v172, v233
v_mfma_f32_32x32x16_bf16 v[184:199], v[116:119], v[68:71], v[184:199]
v_mul_f32 v173, v173, v233
v_mul_f32 v174, v174, v233
v_mul_f32 v175, v175, v233
v_cvt_pk_bf16_f32 v172, v172, v173
v_cvt_pk_bf16_f32 v173, v174, v175
ds_write_b64 v2, v[172:173] offset:16
v_mul_f32 v176, v176, v234
v_mul_f32 v177, v177, v234
v_mfma_f32_32x32x16_bf16 v[184:199], v[120:123], v[72:75], v[184:199]
v_mul_f32 v178, v178, v234
v_mul_f32 v179, v179, v234
v_cvt_pk_bf16_f32 v176, v176, v177
v_cvt_pk_bf16_f32 v177, v178, v179
ds_write_b64 v2, v[176:177] offset:32
v_mul_f32 v180, v180, v235
v_mul_f32 v181, v181, v235
v_mul_f32 v182, v182, v235
v_mfma_f32_32x32x16_bf16 v[200:215], v[124:127], v[68:71], 0
v_mul_f32 v183, v183, v235
v_cvt_pk_bf16_f32 v180, v180, v181
v_cvt_pk_bf16_f32 v181, v182, v183
ds_write_b64 v2, v[180:181] offset:48
s_mov_b32 s46, 0
buffer_store_dwordx4 v[16:19], v7, s[24:27], s46 offen offset:0 sc1
s_mov_b32 s46, 32768
buffer_store_dwordx4 v[20:23], v7, s[24:27], s46 offen offset:0 sc1
v_mfma_f32_32x32x16_bf16 v[200:215], v[128:131], v[72:75], v[200:215]
s_mov_b32 s46, 65536
buffer_store_dwordx4 v[24:27], v7, s[24:27], s46 offen offset:0 sc1
s_mov_b32 s46, 98304
buffer_store_dwordx4 v[28:31], v7, s[24:27], s46 offen offset:0 sc1
s_mov_b32 s46, 131072
buffer_store_dwordx4 v[32:35], v7, s[24:27], s46 offen offset:0 sc1
v_mfma_f32_32x32x16_bf16 v[216:231], v[132:135], v[76:79], v[152:167]
v_mul_f32 v184, v184, v236
v_mul_f32 v185, v185, v236
v_mul_f32 v186, v186, v236
v_mul_f32 v187, v187, v236
v_cvt_pk_bf16_f32 v184, v184, v185
v_cvt_pk_bf16_f32 v185, v186, v187
ds_write_b64 v2, v[184:185] offset:64
v_mul_f32 v188, v188, v237
v_mul_f32 v189, v189, v237
v_mfma_f32_32x32x16_bf16 v[216:231], v[136:139], v[80:83], v[216:231]
v_mul_f32 v190, v190, v237
v_mul_f32 v191, v191, v237
v_cvt_pk_bf16_f32 v188, v188, v189
v_cvt_pk_bf16_f32 v189, v190, v191
ds_write_b64 v2, v[188:189] offset:80
v_mul_f32 v192, v192, v238
v_mul_f32 v193, v193, v238
v_mul_f32 v194, v194, v238
v_mul_f32 v195, v195, v238
v_mfma_f32_32x32x16_bf16 v[216:231], v[140:143], v[84:87], v[216:231]
v_cvt_pk_bf16_f32 v192, v192, v193
v_cvt_pk_bf16_f32 v193, v194, v195
ds_write_b64 v2, v[192:193] offset:96
v_mul_f32 v196, v196, v239
v_mul_f32 v197, v197, v239
v_mul_f32 v198, v198, v239
v_mul_f32 v199, v199, v239
v_cvt_pk_bf16_f32 v196, v196, v197
v_cvt_pk_bf16_f32 v197, v198, v199
v_mfma_f32_32x32x16_bf16 v[216:231], v[144:147], v[88:91], v[216:231]
ds_write_b64 v2, v[196:197] offset:112
v_mul_f32 v200, v200, v240
v_mul_f32 v201, v201, v240
v_mul_f32 v202, v202, v240
v_mul_f32 v203, v203, v240
v_cvt_pk_bf16_f32 v200, v200, v201
v_cvt_pk_bf16_f32 v201, v202, v203
ds_write_b64 v2, v[200:201] offset:128
v_mul_f32 v204, v204, v241
v_mfma_f32_32x32x16_bf16 v[216:231], v[148:151], v[92:95], v[216:231]
v_mul_f32 v205, v205, v241
v_mul_f32 v206, v206, v241
v_mul_f32 v207, v207, v241
v_cvt_pk_bf16_f32 v204, v204, v205
v_cvt_pk_bf16_f32 v205, v206, v207
ds_write_b64 v2, v[204:205] offset:144
v_mfma_f32_32x32x16_bf16 v[168:183], v[96:99], v[76:79], 0
v_mfma_f32_32x32x16_bf16 v[168:183], v[100:103], v[80:83], v[168:183]
s_nop 3
v_rcp_f32 v242, v216
v_rcp_f32 v243, v217
v_rcp_f32 v244, v218
v_rcp_f32 v245, v219
v_mfma_f32_32x32x16_bf16 v[168:183], v[104:107], v[84:87], v[168:183]
v_rcp_f32 v246, v220
v_rcp_f32 v247, v221
v_rcp_f32 v248, v222
v_rcp_f32 v249, v223
v_mfma_f32_32x32x16_bf16 v[184:199], v[108:111], v[80:83], 0
v_rcp_f32 v250, v224
v_rcp_f32 v251, v225
v_mfma_f32_32x32x16_bf16 v[184:199], v[112:115], v[84:87], v[184:199]
s_nop 3
v_mul_f32 v168, v168, v242
v_mul_f32 v169, v169, v242
v_mul_f32 v170, v170, v242
v_mul_f32 v171, v171, v242
v_cvt_pk_bf16_f32 v168, v168, v169
v_cvt_pk_bf16_f32 v169, v170, v171
ds_write_b64 v2, v[168:169] offset:5632
v_mul_f32 v172, v172, v243
v_mfma_f32_32x32x16_bf16 v[184:199], v[116:119], v[88:91], v[184:199]
v_mul_f32 v173, v173, v243
v_mul_f32 v174, v174, v243
v_mul_f32 v175, v175, v243
v_cvt_pk_bf16_f32 v172, v172, v173
v_cvt_pk_bf16_f32 v173, v174, v175
ds_write_b64 v2, v[172:173] offset:5648
v_mul_f32 v176, v176, v244
v_mul_f32 v177, v177, v244
v_mfma_f32_32x32x16_bf16 v[184:199], v[120:123], v[92:95], v[184:199]
v_mul_f32 v178, v178, v244
v_mul_f32 v179, v179, v244
v_cvt_pk_bf16_f32 v176, v176, v177
v_cvt_pk_bf16_f32 v177, v178, v179
ds_write_b64 v2, v[176:177] offset:5664
v_mul_f32 v180, v180, v245
v_mul_f32 v181, v181, v245
v_mul_f32 v182, v182, v245
v_mfma_f32_32x32x16_bf16 v[200:215], v[124:127], v[88:91], 0
v_mul_f32 v183, v183, v245
v_cvt_pk_bf16_f32 v180, v180, v181
v_cvt_pk_bf16_f32 v181, v182, v183
ds_write_b64 v2, v[180:181] offset:5680
s_mov_b32 s46, 163840
buffer_store_dwordx4 v[36:39], v7, s[24:27], s46 offen offset:0 sc1
s_mov_b32 s46, 196608
buffer_store_dwordx4 v[40:43], v7, s[24:27], s46 offen offset:0 sc1
v_mfma_f32_32x32x16_bf16 v[200:215], v[128:131], v[92:95], v[200:215]
s_mov_b32 s46, 229376
buffer_store_dwordx4 v[44:47], v7, s[24:27], s46 offen offset:0 sc1
s_mov_b32 s46, 262144
buffer_store_dwordx4 v[48:51], v7, s[24:27], s46 offen offset:0 sc1
s_mov_b32 s46, 294912
buffer_store_dwordx4 v[52:55], v7, s[24:27], s46 offen offset:0 sc1
v_mul_f32 v184, v184, v246
v_mul_f32 v185, v185, v246
v_mul_f32 v186, v186, v246
v_mul_f32 v187, v187, v246
v_cvt_pk_bf16_f32 v184, v184, v185
v_cvt_pk_bf16_f32 v185, v186, v187
ds_write_b64 v2, v[184:185] offset:5696
v_mul_f32 v188, v188, v247
v_mul_f32 v189, v189, v247
v_mul_f32 v190, v190, v247
v_mul_f32 v191, v191, v247
v_cvt_pk_bf16_f32 v188, v188, v189
v_cvt_pk_bf16_f32 v189, v190, v191
ds_write_b64 v2, v[188:189] offset:5712
v_mul_f32 v192, v192, v248
v_mul_f32 v193, v193, v248
v_mul_f32 v194, v194, v248
v_mul_f32 v195, v195, v248
v_cvt_pk_bf16_f32 v192, v192, v193
v_cvt_pk_bf16_f32 v193, v194, v195
ds_write_b64 v2, v[192:193] offset:5728
v_mul_f32 v196, v196, v249
v_mul_f32 v197, v197, v249
v_mul_f32 v198, v198, v249
v_mul_f32 v199, v199, v249
v_cvt_pk_bf16_f32 v196, v196, v197
v_cvt_pk_bf16_f32 v197, v198, v199
ds_write_b64 v2, v[196:197] offset:5744
v_mul_f32 v200, v200, v250
v_mul_f32 v201, v201, v250
v_mul_f32 v202, v202, v250
v_mul_f32 v203, v203, v250
v_cvt_pk_bf16_f32 v200, v200, v201
v_cvt_pk_bf16_f32 v201, v202, v203
ds_write_b64 v2, v[200:201] offset:5760
v_mul_f32 v204, v204, v251
v_mul_f32 v205, v205, v251
v_mul_f32 v206, v206, v251
v_mul_f32 v207, v207, v251
v_cvt_pk_bf16_f32 v204, v204, v205
v_cvt_pk_bf16_f32 v205, v206, v207
ds_write_b64 v2, v[204:205] offset:5776
s_waitcnt lgkmcnt(0)
ds_read_b64_tr_b16 v[56:57], v5 offset:0
ds_read_b64_tr_b16 v[58:59], v5 offset:704
ds_read_b64_tr_b16 v[60:61], v5 offset:16
ds_read_b64_tr_b16 v[62:63], v5 offset:720
ds_read_b64_tr_b16 v[64:65], v5 offset:32
ds_read_b64_tr_b16 v[66:67], v5 offset:736
ds_read_b64_tr_b16 v[68:69], v5 offset:48
ds_read_b64_tr_b16 v[70:71], v5 offset:752
ds_read_b64_tr_b16 v[72:73], v5 offset:64
ds_read_b64_tr_b16 v[74:75], v5 offset:768
ds_read_b64_tr_b16 v[76:77], v5 offset:80
ds_read_b64_tr_b16 v[78:79], v5 offset:784
ds_read_b64_tr_b16 v[80:81], v5 offset:96
ds_read_b64_tr_b16 v[82:83], v5 offset:800
ds_read_b64_tr_b16 v[84:85], v5 offset:112
ds_read_b64_tr_b16 v[86:87], v5 offset:816
ds_read_b64_tr_b16 v[88:89], v5 offset:128
ds_read_b64_tr_b16 v[90:91], v5 offset:832
ds_read_b64_tr_b16 v[92:93], v5 offset:144
ds_read_b64_tr_b16 v[94:95], v5 offset:848
s_waitcnt lgkmcnt(0)
s_mov_b32 s46, 0
buffer_store_dwordx4 v[56:59], v7, s[24:27], s46 offen offset:128 sc1
s_mov_b32 s46, 32768
buffer_store_dwordx4 v[60:63], v7, s[24:27], s46 offen offset:128 sc1
s_mov_b32 s46, 65536
buffer_store_dwordx4 v[64:67], v7, s[24:27], s46 offen offset:128 sc1
s_mov_b32 s46, 98304
buffer_store_dwordx4 v[68:71], v7, s[24:27], s46 offen offset:128 sc1
s_mov_b32 s46, 131072
buffer_store_dwordx4 v[72:75], v7, s[24:27], s46 offen offset:128 sc1
s_mov_b32 s46, 163840
buffer_store_dwordx4 v[76:79], v7, s[24:27], s46 offen offset:128 sc1
s_mov_b32 s46, 196608
buffer_store_dwordx4 v[80:83], v7, s[24:27], s46 offen offset:128 sc1
s_mov_b32 s46, 229376
buffer_store_dwordx4 v[84:87], v7, s[24:27], s46 offen offset:128 sc1
s_mov_b32 s46, 262144
buffer_store_dwordx4 v[88:91], v7, s[24:27], s46 offen offset:128 sc1
s_mov_b32 s46, 294912
buffer_store_dwordx4 v[92:95], v7, s[24:27], s46 offen offset:128 sc1
s_branch cC
ckv:
s_mul_i32 s56, s44, 1024
s_add_u32 s56, s56, 2048
s_mov_b32 s57, 15
s_mov_b32 s58, 43008
s_mov_b32 s59, 0
s_or_b32 s45, s2, s42
s_cmp_lg_u32 s45, 0
s_cbranch_scc1 ckv2
s_waitcnt lgkmcnt(0)
s_add_u32 s8, s14, 15728640
s_addc_u32 s9, s15, 0
s_mov_b32 s10, 65536
s_mov_b32 s11, 0x00020000
s_mov_b32 s24, s94
s_mov_b32 s25, s95
s_mov_b32 s26, 256
s_mov_b32 s27, 0x00020000
v_mul_u32_u24 v2, 256, v1
v_mov_b32 v3, 0
buffer_store_dword v3, v2, s[8:11], 0 offen sc1
s_mov_b32 s45, 16384
buffer_store_dword v3, v2, s[8:11], s45 offen sc1
s_mov_b32 s45, 32768
buffer_store_dword v3, v2, s[8:11], s45 offen sc1
s_mov_b32 s45, 49152
buffer_store_dword v3, v2, s[8:11], s45 offen sc1
v_lshlrev_b32 v2, 7, v1
v_mov_b32 v4, 1
s_waitcnt vmcnt(0)
buffer_store_dword v4, v2, s[24:27], 0 offen sc1
ckv2:
s_lshl_b32 s60, s42, 12
v_and_b32 v2, 31, v1
v_lshrrev_b32 v3, 5, v1
v_lshrrev_b32 v4, 1, v2
v_and_b32 v4, 7, v4
v_lshlrev_b32 v5, 7, v2
v_add_u32 v5, s60, v5
v_bfe_u32 v6, v1, 2, 2
v_lshl_add_u32 v6, v3, 3, v6
v_mul_u32_u24 v6, 320, v6
v_bfe_u32 v7, v1, 4, 1
v_lshlrev_b32 v7, 5, v7
v_and_b32 v8, 3, v1
v_lshl_add_u32 v7, v8, 3, v7
v_add_u32 v6, v6, v7
v_add_u32 v6, 16384, v6
s_add_u32 s45, s42, 0
s_and_b32 s45, s45, 3
s_lshl_b32 s46, s45, 1
s_mul_i32 s45, s45, 5120
v_add_u32 v7, s46, v3
v_xor_b32 v7, v7, v4
v_lshl_add_u32 v20, v7, 4, v5
v_add_u32 v24, s45, v6
v_mov_b32 v28, v20
v_mov_b32 v32, v24
s_add_u32 s45, s42, 1
s_and_b32 s45, s45, 3
s_lshl_b32 s46, s45, 1
s_mul_i32 s45, s45, 5120
v_add_u32 v7, s46, v3
v_xor_b32 v7, v7, v4
v_lshl_add_u32 v21, v7, 4, v5
v_add_u32 v25, s45, v6
v_mov_b32 v29, v21
v_mov_b32 v33, v25
s_add_u32 s45, s42, 2
s_and_b32 s45, s45, 3
s_lshl_b32 s46, s45, 1
s_mul_i32 s45, s45, 5120
v_add_u32 v7, s46, v3
v_xor_b32 v7, v7, v4
v_lshl_add_u32 v22, v7, 4, v5
v_add_u32 v26, s45, v6
v_mov_b32 v30, v22
v_mov_b32 v34, v26
s_add_u32 s45, s42, 3
s_and_b32 s45, s45, 3
s_lshl_b32 s46, s45, 1
s_mul_i32 s45, s45, 5120
v_add_u32 v7, s46, v3
v_xor_b32 v7, v7, v4
v_lshl_add_u32 v23, v7, 4, v5
v_add_u32 v27, s45, v6
v_mov_b32 v31, v23
v_mov_b32 v35, v27
s_mov_b32 s55, 0x3f803f80
s_mov_b32 s50, 0
s_mov_b32 s54, 0
v_mov_b32 v96, 0
v_mov_b32 v97, 0
v_mov_b32 v98, 0
v_mov_b32 v99, 0
v_mov_b32 v100, 0
v_mov_b32 v101, 0
v_mov_b32 v102, 0
v_mov_b32 v103, 0
v_mov_b32 v104, 0
v_mov_b32 v105, 0
v_mov_b32 v106, 0
v_mov_b32 v107, 0
v_mov_b32 v108, 0
v_mov_b32 v109, 0
v_mov_b32 v110, 0
v_mov_b32 v111, 0
v_mov_b32 v112, 0
v_mov_b32 v113, 0
v_mov_b32 v114, 0
v_mov_b32 v115, 0
v_mov_b32 v116, 0
v_mov_b32 v117, 0
v_mov_b32 v118, 0
v_mov_b32 v119, 0
v_mov_b32 v120, 0
v_mov_b32 v121, 0
v_mov_b32 v122, 0
v_mov_b32 v123, 0
v_mov_b32 v124, 0
v_mov_b32 v125, 0
v_mov_b32 v126, 0
v_mov_b32 v127, 0
v_mov_b32 v128, 0
v_mov_b32 v129, 0
v_mov_b32 v130, 0
v_mov_b32 v131, 0
v_mov_b32 v132, 0
v_mov_b32 v133, 0
v_mov_b32 v134, 0
v_mov_b32 v135, 0
v_mov_b32 v136, 0
v_mov_b32 v137, 0
v_mov_b32 v138, 0
v_mov_b32 v139, 0
v_mov_b32 v140, 0
v_mov_b32 v141, 0
v_mov_b32 v142, 0
v_mov_b32 v143, 0
v_mov_b32 v144, 0
v_mov_b32 v145, 0
v_mov_b32 v146, 0
v_mov_b32 v147, 0
v_mov_b32 v148, 0
v_mov_b32 v149, 0
v_mov_b32 v150, 0
v_mov_b32 v151, 0
v_mov_b32 v152, 0
v_mov_b32 v153, 0
v_mov_b32 v154, 0
v_mov_b32 v155, 0
v_mov_b32 v156, 0
v_mov_b32 v157, 0
v_mov_b32 v158, 0
v_mov_b32 v159, 0
v_mov_b32 v160, 0
v_mov_b32 v161, 0
v_mov_b32 v162, 0
v_mov_b32 v163, 0
v_mov_b32 v164, 0
v_mov_b32 v165, 0
v_mov_b32 v166, 0
v_mov_b32 v167, 0
v_mov_b32 v168, 0
v_mov_b32 v169, 0
v_mov_b32 v170, 0
v_mov_b32 v171, 0
v_mov_b32 v172, 0
v_mov_b32 v173, 0
v_mov_b32 v174, 0
v_mov_b32 v175, 0
v_mov_b32 v180, 0
v_mov_b32 v181, 0
v_mov_b32 v182, 0
v_mov_b32 v183, 0
v_mov_b32 v184, 0
v_mov_b32 v185, 0
v_mov_b32 v186, 0
v_mov_b32 v187, 0
v_mov_b32 v188, 0
v_mov_b32 v189, 0
v_mov_b32 v190, 0
v_mov_b32 v191, 0
v_mov_b32 v192, 0
v_mov_b32 v193, 0
v_mov_b32 v194, 0
v_mov_b32 v195, 0
v_mov_b32 v196, 0
v_mov_b32 v197, 0
v_mov_b32 v198, 0
v_mov_b32 v199, 0
v_and_b32 v2, 15, v1
v_bfe_u32 v3, v1, 4, 1
v_cmp_eq_u32 vcc, v2, v3
v_mov_b32 v4, s55
s_nop 0
v_cndmask_b32 v44, 0, v4, vcc
v_cndmask_b32 v45, 0, v4, vcc
v_cndmask_b32 v46, 0, v4, vcc
v_cndmask_b32 v47, 0, v4, vcc
v_and_b32 v2, 31, v1
s_mul_i32 s45, s42, 7168
s_add_u32 s45, s45, 110592
v_lshrrev_b32 v3, 5, v1
v_lshlrev_b32 v3, 2, v3
v_mov_b32 v8, s45
v_add_u32 v8, 6912, v8
v_lshl_add_u32 v244, v3, 2, s45
v_add_u32 v4, -16, v2
v_mul_i32_i24 v10, 80, v4
v_add_u32 v10, s45, v10
v_mul_i32_i24 v5, 3277, v4
v_ashrrev_i32 v5, 16, v5
v_mul_i32_i24 v5, 20, v5
v_sub_u32 v14, v3, v5
v_add_u32 v4, 16, v2
v_mul_i32_i24 v11, 80, v4
v_add_u32 v11, s45, v11
v_mul_i32_i24 v5, 3277, v4
v_ashrrev_i32 v5, 16, v5
v_mul_i32_i24 v5, 20, v5
v_sub_u32 v15, v3, v5
v_add_u32 v4, 48, v2
v_mul_i32_i24 v12, 80, v4
v_add_u32 v12, s45, v12
v_mul_i32_i24 v5, 3277, v4
v_ashrrev_i32 v5, 16, v5
v_mul_i32_i24 v5, 20, v5
v_sub_u32 v16, v3, v5
v_add_u32 v4, 0, v14
v_cmp_gt_u32 vcc, 20, v4
v_lshl_add_u32 v5, v4, 2, v10
s_nop 0
v_cndmask_b32 v224, v8, v5, vcc
v_add_u32 v4, 8, v14
v_cmp_gt_u32 vcc, 20, v4
v_lshl_add_u32 v5, v4, 2, v10
s_nop 0
v_cndmask_b32 v225, v8, v5, vcc
v_add_u32 v4, 16, v14
v_cmp_gt_u32 vcc, 20, v4
v_lshl_add_u32 v5, v4, 2, v10
s_nop 0
v_cndmask_b32 v226, v8, v5, vcc
v_add_u32 v4, 24, v14
v_cmp_gt_u32 vcc, 20, v4
v_lshl_add_u32 v5, v4, 2, v10
s_nop 0
v_cndmask_b32 v227, v8, v5, vcc
v_add_u32 v4, 0, v15
v_cmp_gt_u32 vcc, 20, v4
v_lshl_add_u32 v5, v4, 2, v11
s_nop 0
v_cndmask_b32 v228, v8, v5, vcc
v_add_u32 v4, 8, v15
v_cmp_gt_u32 vcc, 20, v4
v_lshl_add_u32 v5, v4, 2, v11
s_nop 0
v_cndmask_b32 v229, v8, v5, vcc
v_add_u32 v4, 16, v15
v_cmp_gt_u32 vcc, 20, v4
v_lshl_add_u32 v5, v4, 2, v11
s_nop 0
v_cndmask_b32 v230, v8, v5, vcc
v_add_u32 v4, 24, v15
v_cmp_gt_u32 vcc, 20, v4
v_lshl_add_u32 v5, v4, 2, v11
s_nop 0
v_cndmask_b32 v231, v8, v5, vcc
v_add_u32 v4, 32, v15
v_cmp_gt_u32 vcc, 20, v4
v_lshl_add_u32 v5, v4, 2, v11
s_nop 0
v_cndmask_b32 v232, v8, v5, vcc
v_add_u32 v4, 40, v15
v_cmp_gt_u32 vcc, 20, v4
v_lshl_add_u32 v5, v4, 2, v11
s_nop 0
v_cndmask_b32 v233, v8, v5, vcc
v_add_u32 v4, 48, v15
v_cmp_gt_u32 vcc, 20, v4
v_lshl_add_u32 v5, v4, 2, v11
s_nop 0
v_cndmask_b32 v234, v8, v5, vcc
v_add_u32 v4, 56, v15
v_cmp_gt_u32 vcc, 20, v4
v_lshl_add_u32 v5, v4, 2, v11
s_nop 0
v_cndmask_b32 v235, v8, v5, vcc
v_add_u32 v4, 32, v16
v_cmp_gt_u32 vcc, 20, v4
v_lshl_add_u32 v5, v4, 2, v12
s_nop 0
v_cndmask_b32 v236, v8, v5, vcc
v_add_u32 v4, 40, v16
v_cmp_gt_u32 vcc, 20, v4
v_lshl_add_u32 v5, v4, 2, v12
s_nop 0
v_cndmask_b32 v237, v8, v5, vcc
v_add_u32 v4, 48, v16
v_cmp_gt_u32 vcc, 20, v4
v_lshl_add_u32 v5, v4, 2, v12
s_nop 0
v_cndmask_b32 v238, v8, v5, vcc
v_add_u32 v4, 56, v16
v_cmp_gt_u32 vcc, 20, v4
v_lshl_add_u32 v5, v4, 2, v12
s_nop 0
v_cndmask_b32 v239, v8, v5, vcc
v_add_u32 v4, 64, v16
v_cmp_gt_u32 vcc, 20, v4
v_lshl_add_u32 v5, v4, 2, v12
s_nop 0
v_cndmask_b32 v240, v8, v5, vcc
v_add_u32 v4, 72, v16
v_cmp_gt_u32 vcc, 20, v4
v_lshl_add_u32 v5, v4, 2, v12
s_nop 0
v_cndmask_b32 v241, v8, v5, vcc
v_add_u32 v4, 80, v16
v_cmp_gt_u32 vcc, 20, v4
v_lshl_add_u32 v5, v4, 2, v12
s_nop 0
v_cndmask_b32 v242, v8, v5, vcc
v_add_u32 v4, 88, v16
v_cmp_gt_u32 vcc, 20, v4
v_lshl_add_u32 v5, v4, 2, v12
s_nop 0
v_cndmask_b32 v243, v8, v5, vcc
s_waitcnt lgkmcnt(0)
s_add_u32 s24, s14, 11534336
s_addc_u32 s25, s15, 0
s_mov_b32 s26, 860160
s_mov_b32 s27, 0x00020000
s_barrier
ds_read_b128 v[48:51], v28
ds_read_b64_tr_b16 v[52:53], v32 offset:0
ds_read_b64_tr_b16 v[54:55], v32 offset:1280
ds_read_b64_tr_b16 v[56:57], v32 offset:64
ds_read_b64_tr_b16 v[58:59], v32 offset:1344
ds_read_b64_tr_b16 v[60:61], v32 offset:128
ds_read_b64_tr_b16 v[62:63], v32 offset:1408
ds_read_b64_tr_b16 v[64:65], v32 offset:192
ds_read_b64_tr_b16 v[66:67], v32 offset:1472
ds_read_b64_tr_b16 v[68:69], v32 offset:256
ds_read_b64_tr_b16 v[70:71], v32 offset:1536
p0kv_loop:
s_add_u32 s50, s50, 1
s_add_u32 s54, s54, 36864
s_cmp_ge_u32 s54, 110592
s_cselect_b32 s54, 0, s54
s_waitcnt lgkmcnt(8)
v_mfma_f32_32x32x16_bf16 v[96:111], v[48:51], v[52:55], v[96:111]
ds_read_b128 v[72:75], v29
ds_read_b64_tr_b16 v[76:77], v33 offset:0
ds_read_b64_tr_b16 v[78:79], v33 offset:1280
v_mfma_f32_16x16x32_bf16 v[180:183], v[44:47], v[52:55], v[180:183]
s_waitcnt lgkmcnt(9)
v_mfma_f32_32x32x16_bf16 v[112:127], v[48:51], v[56:59], v[112:127]
ds_read_b64_tr_b16 v[80:81], v33 offset:64
ds_read_b64_tr_b16 v[82:83], v33 offset:1344
v_mfma_f32_16x16x32_bf16 v[184:187], v[44:47], v[56:59], v[184:187]
s_waitcnt lgkmcnt(9)
v_mfma_f32_32x32x16_bf16 v[128:143], v[48:51], v[60:63], v[128:143]
ds_read_b64_tr_b16 v[84:85], v33 offset:128
ds_read_b64_tr_b16 v[86:87], v33 offset:1408
v_mfma_f32_16x16x32_bf16 v[188:191], v[44:47], v[60:63], v[188:191]
s_waitcnt lgkmcnt(9)
v_mfma_f32_32x32x16_bf16 v[144:159], v[48:51], v[64:67], v[144:159]
ds_read_b64_tr_b16 v[88:89], v33 offset:192
ds_read_b64_tr_b16 v[90:91], v33 offset:1472
v_add_u32 v28, s54, v20
v_mfma_f32_16x16x32_bf16 v[192:195], v[44:47], v[64:67], v[192:195]
s_waitcnt lgkmcnt(9)
v_mfma_f32_32x32x16_bf16 v[160:175], v[48:51], v[68:71], v[160:175]
ds_read_b64_tr_b16 v[92:93], v33 offset:256
ds_read_b64_tr_b16 v[94:95], v33 offset:1536
v_add_u32 v32, s54, v24
v_mfma_f32_16x16x32_bf16 v[196:199], v[44:47], v[68:71], v[196:199]
s_waitcnt lgkmcnt(8)
v_mfma_f32_32x32x16_bf16 v[96:111], v[72:75], v[76:79], v[96:111]
ds_read_b128 v[48:51], v30
ds_read_b64_tr_b16 v[52:53], v34 offset:0
ds_read_b64_tr_b16 v[54:55], v34 offset:1280
s_waitcnt lgkmcnt(9)
v_mfma_f32_32x32x16_bf16 v[112:127], v[72:75], v[80:83], v[112:127]
ds_read_b64_tr_b16 v[56:57], v34 offset:64
ds_read_b64_tr_b16 v[58:59], v34 offset:1344
s_waitcnt lgkmcnt(9)
v_mfma_f32_32x32x16_bf16 v[128:143], v[72:75], v[84:87], v[128:143]
ds_read_b64_tr_b16 v[60:61], v34 offset:128
ds_read_b64_tr_b16 v[62:63], v34 offset:1408
s_waitcnt lgkmcnt(9)
v_mfma_f32_32x32x16_bf16 v[144:159], v[72:75], v[88:91], v[144:159]
ds_read_b64_tr_b16 v[64:65], v34 offset:192
ds_read_b64_tr_b16 v[66:67], v34 offset:1472
v_add_u32 v29, s54, v21
s_waitcnt lgkmcnt(9)
v_mfma_f32_32x32x16_bf16 v[160:175], v[72:75], v[92:95], v[160:175]
ds_read_b64_tr_b16 v[68:69], v34 offset:256
ds_read_b64_tr_b16 v[70:71], v34 offset:1536
v_add_u32 v33, s54, v25
s_waitcnt lgkmcnt(8)
v_mfma_f32_32x32x16_bf16 v[96:111], v[48:51], v[52:55], v[96:111]
ds_read_b128 v[72:75], v31
ds_read_b64_tr_b16 v[76:77], v35 offset:0
ds_read_b64_tr_b16 v[78:79], v35 offset:1280
ds_read_b64_tr_b16 v[80:81], v35 offset:64
s_waitcnt lgkmcnt(10)
v_mfma_f32_32x32x16_bf16 v[112:127], v[48:51], v[56:59], v[112:127]
ds_read_b64_tr_b16 v[82:83], v35 offset:1344
ds_read_b64_tr_b16 v[84:85], v35 offset:128
ds_read_b64_tr_b16 v[86:87], v35 offset:1408
ds_read_b64_tr_b16 v[88:89], v35 offset:192
s_waitcnt lgkmcnt(12)
v_mfma_f32_32x32x16_bf16 v[128:143], v[48:51], v[60:63], v[128:143]
ds_read_b64_tr_b16 v[90:91], v35 offset:1472
ds_read_b64_tr_b16 v[92:93], v35 offset:256
ds_read_b64_tr_b16 v[94:95], v35 offset:1536
s_waitcnt lgkmcnt(13)
v_mfma_f32_32x32x16_bf16 v[144:159], v[48:51], v[64:67], v[144:159]
v_add_u32 v30, s54, v22
s_waitcnt lgkmcnt(11)
v_mfma_f32_32x32x16_bf16 v[160:175], v[48:51], v[68:71], v[160:175]
v_add_u32 v34, s54, v26
s_waitcnt lgkmcnt(0)
s_barrier
v_mfma_f32_32x32x16_bf16 v[96:111], v[72:75], v[76:79], v[96:111]
ds_read_b128 v[48:51], v28
ds_read_b64_tr_b16 v[52:53], v32 offset:0
ds_read_b64_tr_b16 v[54:55], v32 offset:1280
v_mfma_f32_32x32x16_bf16 v[112:127], v[72:75], v[80:83], v[112:127]
ds_read_b64_tr_b16 v[56:57], v32 offset:64
ds_read_b64_tr_b16 v[58:59], v32 offset:1344
v_mfma_f32_32x32x16_bf16 v[128:143], v[72:75], v[84:87], v[128:143]
ds_read_b64_tr_b16 v[60:61], v32 offset:128
ds_read_b64_tr_b16 v[62:63], v32 offset:1408
v_mfma_f32_32x32x16_bf16 v[144:159], v[72:75], v[88:91], v[144:159]
ds_read_b64_tr_b16 v[64:65], v32 offset:192
ds_read_b64_tr_b16 v[66:67], v32 offset:1472
v_add_u32 v31, s54, v23
v_mfma_f32_32x32x16_bf16 v[160:175], v[72:75], v[92:95], v[160:175]
ds_read_b64_tr_b16 v[68:69], v32 offset:256
ds_read_b64_tr_b16 v[70:71], v32 offset:1536
v_add_u32 v35, s54, v27
s_cmp_lt_u32 s50, 10
s_cbranch_scc1 p0kv_loop
s_waitcnt lgkmcnt(0)
s_nop 2
v_lshlrev_b32 v2, 2, v1
s_mul_i32 s45, s42, 768
v_add_u32 v3, s45, v2
v_add_u32 v3, 139264, v3
s_mov_b64 exec, 0xffff
ds_write2_b32 v3, v180, v181 offset0:0 offset1:16
ds_write2_b32 v3, v184, v185 offset0:32 offset1:48
ds_write2_b32 v3, v188, v189 offset0:64 offset1:80
ds_write2_b32 v3, v192, v193 offset0:96 offset1:112
ds_write2_b32 v3, v196, v197 offset0:128 offset1:144
s_mov_b64 exec, -1
v_and_b32 v2, 31, v1
v_lshlrev_b32 v2, 2, v2
v_add_u32 v2, 139264, v2
s_lshl_b32 s45, s42, 8
v_add_u32 v3, s45, v2
ds_read_b32 v37, v3 offset:3072
ds_read_b32 v39, v3 offset:3200
s_waitcnt vmcnt(0) lgkmcnt(0)
s_barrier
ds_read_b32 v48, v2 offset:0
ds_read_b32 v49, v2 offset:768
ds_read_b32 v50, v2 offset:1536
ds_read_b32 v51, v2 offset:2304
ds_read_b32 v52, v2 offset:128
ds_read_b32 v53, v2 offset:896
ds_read_b32 v54, v2 offset:1664
ds_read_b32 v55, v2 offset:2432
ds_read_b32 v56, v2 offset:256
ds_read_b32 v57, v2 offset:1024
ds_read_b32 v58, v2 offset:1792
ds_read_b32 v59, v2 offset:2560
ds_read_b32 v60, v2 offset:384
ds_read_b32 v61, v2 offset:1152
ds_read_b32 v62, v2 offset:1920
ds_read_b32 v63, v2 offset:2688
ds_read_b32 v64, v2 offset:512
ds_read_b32 v65, v2 offset:1280
ds_read_b32 v66, v2 offset:2048
ds_read_b32 v67, v2 offset:2816
v_lshrrev_b32 v5, 16, v37
v_or_b32 v72, v5, v37
v_xor_b32 v72, 0x80008000, v72
v_mov_b32 v73, 0
v_mov_b32 v74, 0
v_mov_b32 v75, 0
v_cmp_gt_u32 vcc, 32, v1
v_lshrrev_b32 v4, 5, v1
v_lshlrev_b32 v4, 4, v4
v_add_u32 v4, s45, v4
v_add_u32 v4, 142464, v4
ds_read_b128 v[176:179], v4 offset:0
ds_read_b128 v[180:183], v4 offset:32
ds_read_b128 v[184:187], v4 offset:64
ds_read_b128 v[188:191], v4 offset:96
s_waitcnt lgkmcnt(4)
v_add_f32 v48, v48, v49
v_add_f32 v50, v50, v51
v_add_f32 v48, v48, v50
v_cvt_pk_bf16_f32 v49, v48, v48
v_and_b32 v49, 0xffff0000, v49
v_sub_f32 v50, v48, v49
v_cvt_pk_bf16_f32 v48, v49, v50
v_cndmask_b32 v48, 0, v48, vcc
v_mov_b32 v49, 0
v_mov_b32 v50, 0
v_mov_b32 v51, 0
v_add_f32 v52, v52, v53
v_add_f32 v54, v54, v55
v_add_f32 v52, v52, v54
v_cvt_pk_bf16_f32 v53, v52, v52
v_and_b32 v53, 0xffff0000, v53
v_sub_f32 v54, v52, v53
v_cvt_pk_bf16_f32 v52, v53, v54
v_cndmask_b32 v52, 0, v52, vcc
v_mov_b32 v53, 0
v_mov_b32 v54, 0
v_mov_b32 v55, 0
v_add_f32 v56, v56, v57
v_add_f32 v58, v58, v59
v_add_f32 v56, v56, v58
v_cvt_pk_bf16_f32 v57, v56, v56
v_and_b32 v57, 0xffff0000, v57
v_sub_f32 v58, v56, v57
v_cvt_pk_bf16_f32 v56, v57, v58
v_cndmask_b32 v56, 0, v56, vcc
v_mov_b32 v57, 0
v_mov_b32 v58, 0
v_mov_b32 v59, 0
v_add_f32 v60, v60, v61
v_add_f32 v62, v62, v63
v_add_f32 v60, v60, v62
v_cvt_pk_bf16_f32 v61, v60, v60
v_and_b32 v61, 0xffff0000, v61
v_sub_f32 v62, v60, v61
v_cvt_pk_bf16_f32 v60, v61, v62
v_cndmask_b32 v60, 0, v60, vcc
v_mov_b32 v61, 0
v_mov_b32 v62, 0
v_mov_b32 v63, 0
v_add_f32 v64, v64, v65
v_add_f32 v66, v66, v67
v_add_f32 v64, v64, v66
v_cvt_pk_bf16_f32 v65, v64, v64
v_and_b32 v65, 0xffff0000, v65
v_sub_f32 v66, v64, v65
v_cvt_pk_bf16_f32 v64, v65, v66
v_cndmask_b32 v64, 0, v64, vcc
v_mov_b32 v65, 0
v_mov_b32 v66, 0
v_mov_b32 v67, 0
s_nop 1
v_mfma_f32_32x32x16_bf16 v[160:175], v[72:75], v[64:67], v[160:175]
v_mfma_f32_32x32x16_bf16 v[144:159], v[72:75], v[60:63], v[144:159]
v_mfma_f32_32x32x16_bf16 v[128:143], v[72:75], v[56:59], v[128:143]
v_mfma_f32_32x32x16_bf16 v[112:127], v[72:75], v[52:55], v[112:127]
v_mfma_f32_32x32x16_bf16 v[96:111], v[72:75], v[48:51], v[96:111]
s_mov_b32 s62, 0x358637bd
v_mov_b32 v8, s62
v_mov_b32 v9, s62
v_mov_b32 v10, 0x3fb8aa3b
v_mov_b32 v11, v10
v_mov_b32 v38, v39
s_waitcnt lgkmcnt(0)
v_and_b32 v2, 31, v1
v_cmp_gt_u32 vcc, 16, v2
v_mov_b32 v88, s55
v_mov_b32 v89, s55
v_mov_b32 v90, s55
v_mov_b32 v91, s55
v_pk_mul_f32 v[160:161], v[160:161], v[176:177]
v_pk_mul_f32 v[162:163], v[162:163], v[178:179]
v_cvt_pk_bf16_f32 v80, v160, v161
v_cvt_pk_bf16_f32 v81, v162, v163
v_pk_mul_f32 v[164:165], v[164:165], v[180:181]
v_pk_mul_f32 v[166:167], v[166:167], v[182:183]
v_cvt_pk_bf16_f32 v82, v164, v165
v_cvt_pk_bf16_f32 v83, v166, v167
v_pk_mul_f32 v[168:169], v[168:169], v[184:185]
v_pk_mul_f32 v[170:171], v[170:171], v[186:187]
v_cvt_pk_bf16_f32 v84, v168, v169
v_cvt_pk_bf16_f32 v85, v170, v171
v_pk_mul_f32 v[172:173], v[172:173], v[188:189]
v_pk_mul_f32 v[174:175], v[174:175], v[190:191]
v_cvt_pk_bf16_f32 v86, v172, v173
v_cvt_pk_bf16_f32 v87, v174, v175
v_pk_mul_f32 v[144:145], v[144:145], v[176:177]
v_pk_mul_f32 v[146:147], v[146:147], v[178:179]
v_cvt_pk_bf16_f32 v72, v144, v145
v_cvt_pk_bf16_f32 v73, v146, v147
v_pk_mul_f32 v[148:149], v[148:149], v[180:181]
v_pk_mul_f32 v[150:151], v[150:151], v[182:183]
v_cvt_pk_bf16_f32 v74, v148, v149
v_cvt_pk_bf16_f32 v75, v150, v151
v_pk_mul_f32 v[152:153], v[152:153], v[184:185]
v_pk_mul_f32 v[154:155], v[154:155], v[186:187]
v_cvt_pk_bf16_f32 v76, v152, v153
v_cvt_pk_bf16_f32 v77, v154, v155
v_pk_mul_f32 v[156:157], v[156:157], v[188:189]
v_pk_mul_f32 v[158:159], v[158:159], v[190:191]
v_cvt_pk_bf16_f32 v78, v156, v157
v_cvt_pk_bf16_f32 v79, v158, v159
v_pk_mul_f32 v[12:13], v[128:129], v[176:177]
v_pk_fma_f32 v[128:129], v[128:129], v[176:177], v[8:9]
v_pk_mul_f32 v[14:15], v[130:131], v[178:179]
v_pk_fma_f32 v[130:131], v[130:131], v[178:179], v[8:9]
v_pk_mul_f32 v[4:5], v[128:129], v[10:11]
v_pk_mul_f32 v[6:7], v[130:131], v[10:11]
v_exp_f32 v4, v4 clamp
v_max_f32 v128, s62, v128
v_exp_f32 v5, v5 clamp
v_max_f32 v129, s62, v129
v_exp_f32 v6, v6 clamp
v_max_f32 v130, s62, v130
v_exp_f32 v7, v7 clamp
v_max_f32 v131, s62, v131
v_pk_add_f32 v[128:129], v[128:129], v[4:5]
v_pk_add_f32 v[130:131], v[130:131], v[6:7]
v_cndmask_b32 v128, v12, v128, vcc
v_cndmask_b32 v129, v13, v129, vcc
v_cndmask_b32 v130, v14, v130, vcc
v_cndmask_b32 v131, v15, v131, vcc
v_cvt_pk_bf16_f32 v64, v128, v129
v_cvt_pk_bf16_f32 v65, v130, v131
v_pk_mul_f32 v[12:13], v[132:133], v[180:181]
v_pk_fma_f32 v[132:133], v[132:133], v[180:181], v[8:9]
v_pk_mul_f32 v[14:15], v[134:135], v[182:183]
v_pk_fma_f32 v[134:135], v[134:135], v[182:183], v[8:9]
v_pk_mul_f32 v[4:5], v[132:133], v[10:11]
v_pk_mul_f32 v[6:7], v[134:135], v[10:11]
v_exp_f32 v4, v4 clamp
v_max_f32 v132, s62, v132
v_exp_f32 v5, v5 clamp
v_max_f32 v133, s62, v133
v_exp_f32 v6, v6 clamp
v_max_f32 v134, s62, v134
v_exp_f32 v7, v7 clamp
v_max_f32 v135, s62, v135
v_pk_add_f32 v[132:133], v[132:133], v[4:5]
v_pk_add_f32 v[134:135], v[134:135], v[6:7]
v_cndmask_b32 v132, v12, v132, vcc
v_cndmask_b32 v133, v13, v133, vcc
v_cndmask_b32 v134, v14, v134, vcc
v_cndmask_b32 v135, v15, v135, vcc
v_cvt_pk_bf16_f32 v66, v132, v133
v_cvt_pk_bf16_f32 v67, v134, v135
v_pk_mul_f32 v[12:13], v[136:137], v[184:185]
v_pk_fma_f32 v[136:137], v[136:137], v[184:185], v[8:9]
v_pk_mul_f32 v[14:15], v[138:139], v[186:187]
v_pk_fma_f32 v[138:139], v[138:139], v[186:187], v[8:9]
v_pk_mul_f32 v[4:5], v[136:137], v[10:11]
v_pk_mul_f32 v[6:7], v[138:139], v[10:11]
v_exp_f32 v4, v4 clamp
v_max_f32 v136, s62, v136
v_exp_f32 v5, v5 clamp
v_max_f32 v137, s62, v137
v_exp_f32 v6, v6 clamp
v_max_f32 v138, s62, v138
v_exp_f32 v7, v7 clamp
v_max_f32 v139, s62, v139
v_pk_add_f32 v[136:137], v[136:137], v[4:5]
v_pk_add_f32 v[138:139], v[138:139], v[6:7]
v_cndmask_b32 v136, v12, v136, vcc
v_cndmask_b32 v137, v13, v137, vcc
v_cndmask_b32 v138, v14, v138, vcc
v_cndmask_b32 v139, v15, v139, vcc
v_cvt_pk_bf16_f32 v68, v136, v137
v_cvt_pk_bf16_f32 v69, v138, v139
v_pk_mul_f32 v[12:13], v[140:141], v[188:189]
v_pk_fma_f32 v[140:141], v[140:141], v[188:189], v[8:9]
v_pk_mul_f32 v[14:15], v[142:143], v[190:191]
v_pk_fma_f32 v[142:143], v[142:143], v[190:191], v[8:9]
v_pk_mul_f32 v[4:5], v[140:141], v[10:11]
v_pk_mul_f32 v[6:7], v[142:143], v[10:11]
v_exp_f32 v4, v4 clamp
v_max_f32 v140, s62, v140
v_exp_f32 v5, v5 clamp
v_max_f32 v141, s62, v141
v_exp_f32 v6, v6 clamp
v_max_f32 v142, s62, v142
v_exp_f32 v7, v7 clamp
v_max_f32 v143, s62, v143
v_pk_add_f32 v[140:141], v[140:141], v[4:5]
v_pk_add_f32 v[142:143], v[142:143], v[6:7]
v_cndmask_b32 v140, v12, v140, vcc
v_cndmask_b32 v141, v13, v141, vcc
v_cndmask_b32 v142, v14, v142, vcc
v_cndmask_b32 v143, v15, v143, vcc
v_cvt_pk_bf16_f32 v70, v140, v141
v_cvt_pk_bf16_f32 v71, v142, v143
v_mfma_f32_32x32x16_bf16 v[160:175], v[64:67], v[80:83], 0
v_pk_fma_f32 v[112:113], v[112:113], v[176:177], v[8:9]
v_pk_fma_f32 v[114:115], v[114:115], v[178:179], v[8:9]
v_pk_mul_f32 v[4:5], v[112:113], v[10:11]
v_pk_mul_f32 v[6:7], v[114:115], v[10:11]
v_exp_f32 v4, v4 clamp
v_max_f32 v112, s62, v112
v_exp_f32 v5, v5 clamp
v_max_f32 v113, s62, v113
v_exp_f32 v6, v6 clamp
v_max_f32 v114, s62, v114
v_exp_f32 v7, v7 clamp
v_max_f32 v115, s62, v115
v_pk_add_f32 v[112:113], v[112:113], v[4:5]
v_pk_add_f32 v[114:115], v[114:115], v[6:7]
v_cvt_pk_bf16_f32 v56, v112, v113
v_cvt_pk_bf16_f32 v57, v114, v115
v_mfma_f32_32x32x16_bf16 v[208:223], v[64:67], v[88:91], 0
v_pk_fma_f32 v[116:117], v[116:117], v[180:181], v[8:9]
v_pk_fma_f32 v[118:119], v[118:119], v[182:183], v[8:9]
v_pk_mul_f32 v[4:5], v[116:117], v[10:11]
v_pk_mul_f32 v[6:7], v[118:119], v[10:11]
v_exp_f32 v4, v4 clamp
v_max_f32 v116, s62, v116
v_exp_f32 v5, v5 clamp
v_max_f32 v117, s62, v117
v_exp_f32 v6, v6 clamp
v_max_f32 v118, s62, v118
v_exp_f32 v7, v7 clamp
v_max_f32 v119, s62, v119
v_pk_add_f32 v[116:117], v[116:117], v[4:5]
v_pk_add_f32 v[118:119], v[118:119], v[6:7]
v_cvt_pk_bf16_f32 v58, v116, v117
v_cvt_pk_bf16_f32 v59, v118, v119
v_mfma_f32_32x32x16_bf16 v[160:175], v[68:71], v[84:87], v[160:175]
v_pk_fma_f32 v[120:121], v[120:121], v[184:185], v[8:9]
v_pk_fma_f32 v[122:123], v[122:123], v[186:187], v[8:9]
v_pk_mul_f32 v[4:5], v[120:121], v[10:11]
v_pk_mul_f32 v[6:7], v[122:123], v[10:11]
v_exp_f32 v4, v4 clamp
v_max_f32 v120, s62, v120
v_exp_f32 v5, v5 clamp
v_max_f32 v121, s62, v121
v_exp_f32 v6, v6 clamp
v_max_f32 v122, s62, v122
v_exp_f32 v7, v7 clamp
v_max_f32 v123, s62, v123
v_pk_add_f32 v[120:121], v[120:121], v[4:5]
v_pk_add_f32 v[122:123], v[122:123], v[6:7]
v_cvt_pk_bf16_f32 v60, v120, v121
v_cvt_pk_bf16_f32 v61, v122, v123
v_mfma_f32_32x32x16_bf16 v[208:223], v[68:71], v[88:91], v[208:223]
v_pk_fma_f32 v[124:125], v[124:125], v[188:189], v[8:9]
v_pk_fma_f32 v[126:127], v[126:127], v[190:191], v[8:9]
v_pk_mul_f32 v[4:5], v[124:125], v[10:11]
v_pk_mul_f32 v[6:7], v[126:127], v[10:11]
v_exp_f32 v4, v4 clamp
v_max_f32 v124, s62, v124
v_exp_f32 v5, v5 clamp
v_max_f32 v125, s62, v125
v_exp_f32 v6, v6 clamp
v_max_f32 v126, s62, v126
v_exp_f32 v7, v7 clamp
v_max_f32 v127, s62, v127
v_pk_add_f32 v[124:125], v[124:125], v[4:5]
v_pk_add_f32 v[126:127], v[126:127], v[6:7]
v_cvt_pk_bf16_f32 v62, v124, v125
v_cvt_pk_bf16_f32 v63, v126, v127
v_mfma_f32_32x32x16_bf16 v[128:143], v[56:59], v[72:75], 0
v_mfma_f32_32x32x16_bf16 v[144:159], v[56:59], v[80:83], 0
v_pk_fma_f32 v[96:97], v[96:97], v[176:177], v[8:9]
v_pk_fma_f32 v[98:99], v[98:99], v[178:179], v[8:9]
v_pk_mul_f32 v[4:5], v[96:97], v[10:11]
v_pk_mul_f32 v[6:7], v[98:99], v[10:11]
v_exp_f32 v4, v4 clamp
v_max_f32 v96, s62, v96
v_exp_f32 v5, v5 clamp
v_max_f32 v97, s62, v97
v_exp_f32 v6, v6 clamp
v_max_f32 v98, s62, v98
v_exp_f32 v7, v7 clamp
v_max_f32 v99, s62, v99
v_pk_add_f32 v[96:97], v[96:97], v[4:5]
v_pk_add_f32 v[98:99], v[98:99], v[6:7]
v_cvt_pk_bf16_f32 v48, v96, v97
v_cvt_pk_bf16_f32 v49, v98, v99
v_mfma_f32_32x32x16_bf16 v[192:207], v[56:59], v[88:91], 0
v_mfma_f32_32x32x16_bf16 v[128:143], v[60:63], v[76:79], v[128:143]
v_pk_fma_f32 v[100:101], v[100:101], v[180:181], v[8:9]
v_pk_fma_f32 v[102:103], v[102:103], v[182:183], v[8:9]
v_pk_mul_f32 v[4:5], v[100:101], v[10:11]
v_pk_mul_f32 v[6:7], v[102:103], v[10:11]
v_exp_f32 v4, v4 clamp
v_max_f32 v100, s62, v100
v_exp_f32 v5, v5 clamp
v_max_f32 v101, s62, v101
v_exp_f32 v6, v6 clamp
v_max_f32 v102, s62, v102
v_exp_f32 v7, v7 clamp
v_max_f32 v103, s62, v103
v_pk_add_f32 v[100:101], v[100:101], v[4:5]
v_pk_add_f32 v[102:103], v[102:103], v[6:7]
v_cvt_pk_bf16_f32 v50, v100, v101
v_cvt_pk_bf16_f32 v51, v102, v103
v_mfma_f32_32x32x16_bf16 v[144:159], v[60:63], v[84:87], v[144:159]
v_mfma_f32_32x32x16_bf16 v[192:207], v[60:63], v[88:91], v[192:207]
v_pk_fma_f32 v[104:105], v[104:105], v[184:185], v[8:9]
v_pk_fma_f32 v[106:107], v[106:107], v[186:187], v[8:9]
v_pk_mul_f32 v[4:5], v[104:105], v[10:11]
v_pk_mul_f32 v[6:7], v[106:107], v[10:11]
v_exp_f32 v4, v4 clamp
v_max_f32 v104, s62, v104
v_exp_f32 v5, v5 clamp
v_max_f32 v105, s62, v105
v_exp_f32 v6, v6 clamp
v_max_f32 v106, s62, v106
v_exp_f32 v7, v7 clamp
v_max_f32 v107, s62, v107
v_pk_add_f32 v[104:105], v[104:105], v[4:5]
v_pk_add_f32 v[106:107], v[106:107], v[6:7]
v_cvt_pk_bf16_f32 v52, v104, v105
v_cvt_pk_bf16_f32 v53, v106, v107
v_pk_fma_f32 v[108:109], v[108:109], v[188:189], v[8:9]
v_pk_fma_f32 v[110:111], v[110:111], v[190:191], v[8:9]
v_pk_mul_f32 v[4:5], v[108:109], v[10:11]
v_pk_mul_f32 v[6:7], v[110:111], v[10:11]
v_exp_f32 v4, v4 clamp
v_max_f32 v108, s62, v108
v_exp_f32 v5, v5 clamp
v_max_f32 v109, s62, v109
v_exp_f32 v6, v6 clamp
v_max_f32 v110, s62, v110
v_exp_f32 v7, v7 clamp
v_max_f32 v111, s62, v111
v_pk_add_f32 v[108:109], v[108:109], v[4:5]
v_pk_add_f32 v[110:111], v[110:111], v[6:7]
v_cvt_pk_bf16_f32 v54, v108, v109
v_cvt_pk_bf16_f32 v55, v110, v111
v_mfma_f32_32x32x16_bf16 v[96:111], v[48:51], v[64:67], 0
ds_write_b128 v240, v[160:163]
ds_write_b128 v241, v[164:167]
v_mfma_f32_32x32x16_bf16 v[112:127], v[48:51], v[72:75], 0
ds_write_b128 v242, v[168:171]
ds_write_b128 v243, v[172:175]
v_mfma_f32_32x32x16_bf16 v[176:191], v[48:51], v[88:91], 0
ds_write_b128 v232, v[128:131]
ds_write_b128 v233, v[132:135]
v_mfma_f32_32x32x16_bf16 v[96:111], v[52:55], v[68:71], v[96:111]
ds_write_b128 v234, v[136:139]
ds_write_b128 v235, v[140:143]
v_mfma_f32_32x32x16_bf16 v[112:127], v[52:55], v[76:79], v[112:127]
ds_write_b128 v236, v[144:147]
ds_write_b128 v237, v[148:151]
v_mfma_f32_32x32x16_bf16 v[176:191], v[52:55], v[88:91], v[176:191]
ds_write_b128 v238, v[152:155]
ds_write_b128 v239, v[156:159]
s_nop 3
ds_write_b128 v224, v[96:99]
ds_write_b128 v225, v[100:103]
ds_write_b128 v226, v[104:107]
ds_write_b128 v227, v[108:111]
ds_write_b128 v228, v[112:115]
ds_write_b128 v229, v[116:119]
ds_write_b128 v230, v[120:123]
ds_write_b128 v231, v[124:127]
s_mov_b32 exec_lo, 1
s_mov_b32 exec_hi, 1
ds_write_b128 v244, v[176:179] offset:6400
ds_write_b128 v244, v[180:183] offset:6432
ds_write_b128 v244, v[184:187] offset:6464
ds_write_b128 v244, v[188:191] offset:6496
ds_write_b128 v244, v[192:195] offset:6528
ds_write_b128 v244, v[196:199] offset:6560
ds_write_b128 v244, v[200:203] offset:6592
ds_write_b128 v244, v[204:207] offset:6624
ds_write_b128 v244, v[208:211] offset:6656
ds_write_b128 v244, v[212:215] offset:6688
s_mov_b64 exec, -1
s_waitcnt lgkmcnt(0)
s_barrier
v_lshlrev_b32 v2, 4, v0
v_add_u32 v6, 110592, v2
ds_read_b128 v[48:51], v6 offset:0
ds_read_b128 v[52:55], v6 offset:7168
ds_read_b128 v[56:59], v6 offset:14336
ds_read_b128 v[60:63], v6 offset:21504
ds_read_b128 v[64:67], v6 offset:4096
ds_read_b128 v[68:71], v6 offset:11264
ds_read_b128 v[72:75], v6 offset:18432
ds_read_b128 v[76:79], v6 offset:25600
s_lshl_b32 s45, s43, 3
s_add_u32 s45, s45, s44
s_mul_i32 s45, s45, 6720
v_add_u32 v3, s45, v2
v_add_u32 v4, 4096, v3
v_mov_b32 v5, 1073741824
v_cmp_gt_u32 vcc, 164, v0
s_nop 1
v_cndmask_b32 v4, v5, v4, vcc
s_waitcnt lgkmcnt(0)
v_add_f32 v48, v48, v52
v_add_f32 v56, v56, v60
v_add_f32 v48, v48, v56
v_add_f32 v49, v49, v53
v_add_f32 v57, v57, v61
v_add_f32 v49, v49, v57
v_add_f32 v50, v50, v54
v_add_f32 v58, v58, v62
v_add_f32 v50, v50, v58
v_add_f32 v51, v51, v55
v_add_f32 v59, v59, v63
v_add_f32 v51, v51, v59
buffer_store_dwordx4 v[48:51], v3, s[24:27], 0 offen sc1
v_add_f32 v64, v64, v68
v_add_f32 v72, v72, v76
v_add_f32 v64, v64, v72
v_add_f32 v65, v65, v69
v_add_f32 v73, v73, v77
v_add_f32 v65, v65, v73
v_add_f32 v66, v66, v70
v_add_f32 v74, v74, v78
v_add_f32 v66, v66, v74
v_add_f32 v67, v67, v71
v_add_f32 v75, v75, v79
v_add_f32 v67, v67, v75
buffer_store_dwordx4 v[64:67], v4, s[24:27], 0 offen sc1
s_cmp_eq_u32 s98, 1
s_cbranch_scc1 cO
s_cmp_eq_u32 s98, 2
s_cbranch_scc1 cC
cB:
s_and_b32 s45, s42, 1
s_lshl_b32 s45, s45, 1
s_lshr_b32 s46, s42, 1
s_or_b32 s45, s45, s46
s_mul_i32 s46, s46, 18432
v_lshrrev_b32 v2, 4, v1
v_bfe_u32 v3, v1, 2, 2
v_and_b32 v4, 3, v1
v_lshl_add_u32 v5, v2, 3, v3
v_lshlrev_b32 v5, 7, v5
v_lshl_add_u32 v5, v4, 3, v5
v_add_u32 v5, s46, v5
v_lshrrev_b32 v6, 1, v3
v_and_b32 v7, 1, v2
v_lshl_or_b32 v6, v7, 1, v6
v_xor_b32 v6, s45, v6
v_lshl_add_u32 v20, v6, 5, v5
v_xor_b32 v6, 1, v6
v_lshl_add_u32 v21, v6, 5, v5
s_add_u32 s46, s46, 8192
v_and_b32 v3, 15, v1
v_lshrrev_b32 v4, 1, v3
v_xor_b32 v4, v4, v2
v_lshlrev_b32 v5, 7, v3
v_add_u32 v5, s46, v5
v_lshl_add_u32 v22, v4, 4, v5
v_xor_b32 v4, 4, v4
v_lshl_add_u32 v23, v4, 4, v5
v_mov_b32 v96, 0
v_mov_b32 v97, 0
v_mov_b32 v98, 0
v_mov_b32 v99, 0
v_mov_b32 v100, 0
v_mov_b32 v101, 0
v_mov_b32 v102, 0
v_mov_b32 v103, 0
v_mov_b32 v104, 0
v_mov_b32 v105, 0
v_mov_b32 v106, 0
v_mov_b32 v107, 0
v_mov_b32 v108, 0
v_mov_b32 v109, 0
v_mov_b32 v110, 0
v_mov_b32 v111, 0
v_mov_b32 v112, 0
v_mov_b32 v113, 0
v_mov_b32 v114, 0
v_mov_b32 v115, 0
v_mov_b32 v116, 0
v_mov_b32 v117, 0
v_mov_b32 v118, 0
v_mov_b32 v119, 0
v_mov_b32 v120, 0
v_mov_b32 v121, 0
v_mov_b32 v122, 0
v_mov_b32 v123, 0
v_mov_b32 v124, 0
v_mov_b32 v125, 0
v_mov_b32 v126, 0
v_mov_b32 v127, 0
v_mov_b32 v128, 0
v_mov_b32 v129, 0
v_mov_b32 v130, 0
v_mov_b32 v131, 0
v_mov_b32 v132, 0
v_mov_b32 v133, 0
v_mov_b32 v134, 0
v_mov_b32 v135, 0
s_mov_b32 s54, 36864
s_mov_b32 s50, 0
s_mov_b32 s48, 110592
s_cmp_eq_u32 s98, 3
s_cselect_b32 s48, 147456, s48
v_add_u32 v24, s54, v20
v_add_u32 v25, s54, v21
v_add_u32 v26, s54, v22
v_add_u32 v27, s54, v23
s_add_u32 s54, s54, 36864
s_cmp_ge_u32 s54, s48
s_cselect_b32 s54, 0, s54
s_cmp_eq_u32 s57, 0
s_cbranch_scc1 cB_p0
s_waitcnt vmcnt(0)
cB_p0:
s_barrier
s_cbranch_scc1 cB_np
s_cmp_lg_u32 s42, 0
s_cbranch_scc1 cB_np
s_add_u32 s8, s14, 15728640
s_addc_u32 s9, s15, 0
s_mov_b32 s10, 65536
s_mov_b32 s11, 0x00020000
v_mul_u32_u24 v2, 256, v1
v_mov_b32 v3, s61
s_mov_b32 exec_lo, s57
s_mov_b32 exec_hi, 0
buffer_atomic_add v3, v2, s[8:11], s56 offen sc1
s_mov_b64 exec, -1
cB_np:
s_mov_b32 s61, 1
s_cmp_lg_u32 s98, 3
s_cbranch_scc1 cB_nw
s_add_u32 s36, s14, 5242880
s_addc_u32 s37, s15, 0
s_mov_b32 s38, 3031040
s_mov_b32 s39, 0x00020000
v_and_b32 v6, 3, v1
v_and_b32 v4, 15, v1
v_lshrrev_b32 v2, 4, v1
v_bfe_u32 v3, v1, 2, 2
v_lshl_add_u32 v8, v2, 3, v3
v_mul_u32_u24 v8, 160, v8
v_lshl_add_u32 v8, v6, 3, v8
v_add_u32 v8, 131072, v8
v_mul_u32_u24 v9, 4736, v4
v_lshl_add_u32 v9, v2, 4, v9
s_mul_i32 s49, s97, 378880
s_mul_i32 s44, s96, 160
s_add_u32 s49, s49, s44
s_add_u32 s49, s49, 3456
v_add_u32 v9, s49, v9
v_mov_b32 v11, 1073741824
s_add_u32 s44, s42, 0
s_min_u32 s44, s44, 14
s_mul_i32 s51, s44, 86
s_lshr_b32 s51, s51, 8
s_mul_i32 s52, s51, 3
s_sub_u32 s52, s44, s52
s_mul_i32 s53, s52, 5120
s_lshl_b32 s47, s51, 5
s_add_u32 s53, s53, s47
v_add_u32 v10, s53, v8
ds_read_b64_tr_b16 v[60:61], v10
ds_read_b64_tr_b16 v[62:63], v10 offset:640
s_mul_i32 s53, s51, 75776
s_lshl_b32 s47, s52, 6
s_add_u32 s53, s53, s47
v_add_u32 v50, s53, v9
s_cmp_eq_u32 s52, 2
s_cselect_b32 s47, 32, 64
v_cmp_gt_u32 vcc, s47, v1
s_nop 1
v_cndmask_b32 v50, v11, v50, vcc
s_add_u32 s44, s42, 4
s_min_u32 s44, s44, 14
s_mul_i32 s51, s44, 86
s_lshr_b32 s51, s51, 8
s_mul_i32 s52, s51, 3
s_sub_u32 s52, s44, s52
s_mul_i32 s53, s52, 5120
s_lshl_b32 s47, s51, 5
s_add_u32 s53, s53, s47
v_add_u32 v10, s53, v8
ds_read_b64_tr_b16 v[64:65], v10
ds_read_b64_tr_b16 v[66:67], v10 offset:640
s_mul_i32 s53, s51, 75776
s_lshl_b32 s47, s52, 6
s_add_u32 s53, s53, s47
v_add_u32 v51, s53, v9
s_cmp_eq_u32 s52, 2
s_cselect_b32 s47, 32, 64
v_cmp_gt_u32 vcc, s47, v1
s_nop 1
v_cndmask_b32 v51, v11, v51, vcc
s_add_u32 s44, s42, 8
s_min_u32 s44, s44, 14
s_mul_i32 s51, s44, 86
s_lshr_b32 s51, s51, 8
s_mul_i32 s52, s51, 3
s_sub_u32 s52, s44, s52
s_mul_i32 s53, s52, 5120
s_lshl_b32 s47, s51, 5
s_add_u32 s53, s53, s47
v_add_u32 v10, s53, v8
ds_read_b64_tr_b16 v[68:69], v10
ds_read_b64_tr_b16 v[70:71], v10 offset:640
s_mul_i32 s53, s51, 75776
s_lshl_b32 s47, s52, 6
s_add_u32 s53, s53, s47
v_add_u32 v52, s53, v9
s_cmp_eq_u32 s52, 2
s_cselect_b32 s47, 32, 64
v_cmp_gt_u32 vcc, s47, v1
s_nop 1
v_cndmask_b32 v52, v11, v52, vcc
s_add_u32 s44, s42, 12
s_min_u32 s44, s44, 14
s_mul_i32 s51, s44, 86
s_lshr_b32 s51, s51, 8
s_mul_i32 s52, s51, 3
s_sub_u32 s52, s44, s52
s_mul_i32 s53, s52, 5120
s_lshl_b32 s47, s51, 5
s_add_u32 s53, s53, s47
v_add_u32 v10, s53, v8
ds_read_b64_tr_b16 v[72:73], v10
ds_read_b64_tr_b16 v[74:75], v10 offset:640
s_mul_i32 s53, s51, 75776
s_lshl_b32 s47, s52, 6
s_add_u32 s53, s53, s47
v_add_u32 v53, s53, v9
s_cmp_eq_u32 s52, 2
s_cselect_b32 s47, 32, 64
v_cmp_gt_u32 vcc, s47, v1
s_nop 1
v_cndmask_b32 v53, v11, v53, vcc
s_waitcnt lgkmcnt(0)
buffer_store_dwordx4 v[60:63], v50, s[36:39], 0 offen sc1
buffer_store_dwordx4 v[64:67], v51, s[36:39], 0 offen sc1
buffer_store_dwordx4 v[68:71], v52, s[36:39], 0 offen sc1
buffer_store_dwordx4 v[72:75], v53, s[36:39], 0 offen sc1
cB_nw:
s_add_u32 s24, s14, 5242880
s_addc_u32 s25, s15, 0
s_mov_b32 s26, 3031040
s_mov_b32 s27, 0x00020000
s_mov_b32 s28, s86
s_mov_b32 s29, s87
s_mov_b32 s30, 3456
s_mov_b32 s31, 0x00020000
s_and_b32 s45, s42, 1
s_lshl_b32 s45, s45, 6
s_lshr_b32 s46, s42, 1
s_lshl_b32 s46, s46, 5
s_add_u32 s45, s45, s46
s_lshl_b32 s47, s96, 7
s_add_u32 s45, s45, s47
v_lshrrev_b32 v2, 4, v1
v_lshlrev_b32 v2, 3, v2
v_add_u32 v2, s45, v2
buffer_load_dwordx2 v[18:19], v2, s[28:31], 0 offen
v_subrev_u32 v2, s47, v2
v_and_b32 v3, 15, v1
v_mul_u32_u24 v3, 144, v3
v_add_u32 v3, 147456, v3
v_add_u32 v16, v2, v3
v_lshrrev_b32 v2, 3, v0
v_and_b32 v3, 7, v0
v_mul_u32_u24 v14, 144, v2
v_lshl_add_u32 v14, v3, 4, v14
v_add_u32 v14, 147456, v14
s_mul_i32 s45, s97, 80
v_add_u32 v2, s45, v2
v_mul_u32_u24 v2, 4736, v2
v_lshl_add_u32 v2, v3, 4, v2
v_add_u32 v15, s47, v2
v_mov_b32 v3, 1073741824
v_cmp_gt_u32 vcc, 128, v0
s_nop 1
v_cndmask_b32 v17, v3, v15, vcc
s_barrier
s_barrier
ds_read_b64_tr_b16 v[136:137], v24 offset:0
ds_read_b64_tr_b16 v[138:139], v24 offset:512
ds_read_b64_tr_b16 v[140:141], v25 offset:0
ds_read_b64_tr_b16 v[142:143], v25 offset:512
ds_read_b128 v[152:155], v26 offset:0
ds_read_b128 v[156:159], v26 offset:2048
ds_read_b128 v[160:163], v26 offset:4096
ds_read_b128 v[164:167], v26 offset:6144
ds_read_b128 v[168:171], v26 offset:8192
ds_read_b64_tr_b16 v[144:145], v24 offset:4096
ds_read_b64_tr_b16 v[146:147], v24 offset:4608
ds_read_b64_tr_b16 v[148:149], v25 offset:4096
ds_read_b64_tr_b16 v[150:151], v25 offset:4608
ds_read_b128 v[172:175], v27 offset:0
ds_read_b128 v[176:179], v27 offset:2048
ds_read_b128 v[180:183], v27 offset:4096
ds_read_b128 v[184:187], v27 offset:6144
ds_read_b128 v[188:191], v27 offset:8192
v_add_u32 v24, s54, v20
v_add_u32 v25, s54, v21
v_add_u32 v26, s54, v22
v_add_u32 v27, s54, v23
s_add_u32 s54, s54, 36864
s_cmp_ge_u32 s54, s48
s_cselect_b32 s54, 0, s54
cB_loop:
s_waitcnt lgkmcnt(0)
s_barrier
v_mfma_f32_16x16x32_bf16 v[96:99], v[136:139], v[152:155], v[96:99]
ds_read_b64_tr_b16 v[192:193], v24 offset:0
ds_read_b64_tr_b16 v[194:195], v24 offset:512
v_mfma_f32_16x16x32_bf16 v[116:119], v[140:143], v[152:155], v[116:119]
ds_read_b64_tr_b16 v[196:197], v25 offset:0
v_mfma_f32_16x16x32_bf16 v[100:103], v[136:139], v[156:159], v[100:103]
ds_read_b64_tr_b16 v[198:199], v25 offset:512
ds_read_b128 v[208:211], v26 offset:0
v_mfma_f32_16x16x32_bf16 v[120:123], v[140:143], v[156:159], v[120:123]
ds_read_b128 v[212:215], v26 offset:2048
v_mfma_f32_16x16x32_bf16 v[104:107], v[136:139], v[160:163], v[104:107]
ds_read_b128 v[216:219], v26 offset:4096
ds_read_b128 v[220:223], v26 offset:6144
v_mfma_f32_16x16x32_bf16 v[124:127], v[140:143], v[160:163], v[124:127]
ds_read_b128 v[224:227], v26 offset:8192
v_mfma_f32_16x16x32_bf16 v[108:111], v[136:139], v[164:167], v[108:111]
ds_read_b64_tr_b16 v[200:201], v24 offset:4096
ds_read_b64_tr_b16 v[202:203], v24 offset:4608
v_mfma_f32_16x16x32_bf16 v[128:131], v[140:143], v[164:167], v[128:131]
ds_read_b64_tr_b16 v[204:205], v25 offset:4096
v_mfma_f32_16x16x32_bf16 v[112:115], v[136:139], v[168:171], v[112:115]
ds_read_b64_tr_b16 v[206:207], v25 offset:4608
ds_read_b128 v[228:231], v27 offset:0
v_mfma_f32_16x16x32_bf16 v[132:135], v[140:143], v[168:171], v[132:135]
ds_read_b128 v[232:235], v27 offset:2048
v_mfma_f32_16x16x32_bf16 v[96:99], v[144:147], v[172:175], v[96:99]
ds_read_b128 v[236:239], v27 offset:4096
ds_read_b128 v[240:243], v27 offset:6144
v_mfma_f32_16x16x32_bf16 v[116:119], v[148:151], v[172:175], v[116:119]
ds_read_b128 v[244:247], v27 offset:8192
v_mfma_f32_16x16x32_bf16 v[100:103], v[144:147], v[176:179], v[100:103]
v_mfma_f32_16x16x32_bf16 v[120:123], v[148:151], v[176:179], v[120:123]
v_mfma_f32_16x16x32_bf16 v[104:107], v[144:147], v[180:183], v[104:107]
v_mfma_f32_16x16x32_bf16 v[124:127], v[148:151], v[180:183], v[124:127]
v_mfma_f32_16x16x32_bf16 v[108:111], v[144:147], v[184:187], v[108:111]
v_add_u32 v24, s54, v20
v_add_u32 v25, s54, v21
v_add_u32 v26, s54, v22
v_add_u32 v27, s54, v23
s_add_u32 s54, s54, 36864
s_cmp_ge_u32 s54, s48
s_cselect_b32 s54, 0, s54
v_mfma_f32_16x16x32_bf16 v[128:131], v[148:151], v[184:187], v[128:131]
v_mfma_f32_16x16x32_bf16 v[112:115], v[144:147], v[188:191], v[112:115]
v_mfma_f32_16x16x32_bf16 v[132:135], v[148:151], v[188:191], v[132:135]
s_add_u32 s50, s50, 1
s_cmp_ge_u32 s50, 16
s_cbranch_scc1 cB_done
s_waitcnt lgkmcnt(0)
s_barrier
v_mfma_f32_16x16x32_bf16 v[96:99], v[192:195], v[208:211], v[96:99]
ds_read_b64_tr_b16 v[136:137], v24 offset:0
ds_read_b64_tr_b16 v[138:139], v24 offset:512
v_mfma_f32_16x16x32_bf16 v[116:119], v[196:199], v[208:211], v[116:119]
ds_read_b64_tr_b16 v[140:141], v25 offset:0
v_mfma_f32_16x16x32_bf16 v[100:103], v[192:195], v[212:215], v[100:103]
ds_read_b64_tr_b16 v[142:143], v25 offset:512
ds_read_b128 v[152:155], v26 offset:0
v_mfma_f32_16x16x32_bf16 v[120:123], v[196:199], v[212:215], v[120:123]
ds_read_b128 v[156:159], v26 offset:2048
v_mfma_f32_16x16x32_bf16 v[104:107], v[192:195], v[216:219], v[104:107]
ds_read_b128 v[160:163], v26 offset:4096
ds_read_b128 v[164:167], v26 offset:6144
v_mfma_f32_16x16x32_bf16 v[124:127], v[196:199], v[216:219], v[124:127]
ds_read_b128 v[168:171], v26 offset:8192
v_mfma_f32_16x16x32_bf16 v[108:111], v[192:195], v[220:223], v[108:111]
ds_read_b64_tr_b16 v[144:145], v24 offset:4096
ds_read_b64_tr_b16 v[146:147], v24 offset:4608
v_mfma_f32_16x16x32_bf16 v[128:131], v[196:199], v[220:223], v[128:131]
ds_read_b64_tr_b16 v[148:149], v25 offset:4096
v_mfma_f32_16x16x32_bf16 v[112:115], v[192:195], v[224:227], v[112:115]
ds_read_b64_tr_b16 v[150:151], v25 offset:4608
ds_read_b128 v[172:175], v27 offset:0
v_mfma_f32_16x16x32_bf16 v[132:135], v[196:199], v[224:227], v[132:135]
ds_read_b128 v[176:179], v27 offset:2048
v_mfma_f32_16x16x32_bf16 v[96:99], v[200:203], v[228:231], v[96:99]
ds_read_b128 v[180:183], v27 offset:4096
ds_read_b128 v[184:187], v27 offset:6144
v_mfma_f32_16x16x32_bf16 v[116:119], v[204:207], v[228:231], v[116:119]
ds_read_b128 v[188:191], v27 offset:8192
v_mfma_f32_16x16x32_bf16 v[100:103], v[200:203], v[232:235], v[100:103]
v_mfma_f32_16x16x32_bf16 v[120:123], v[204:207], v[232:235], v[120:123]
v_mfma_f32_16x16x32_bf16 v[104:107], v[200:203], v[236:239], v[104:107]
v_mfma_f32_16x16x32_bf16 v[124:127], v[204:207], v[236:239], v[124:127]
v_mfma_f32_16x16x32_bf16 v[108:111], v[200:203], v[240:243], v[108:111]
v_add_u32 v24, s54, v20
v_add_u32 v25, s54, v21
v_add_u32 v26, s54, v22
v_add_u32 v27, s54, v23
s_add_u32 s54, s54, 36864
s_cmp_ge_u32 s54, s48
s_cselect_b32 s54, 0, s54
v_mfma_f32_16x16x32_bf16 v[128:131], v[204:207], v[240:243], v[128:131]
v_mfma_f32_16x16x32_bf16 v[112:115], v[200:203], v[244:247], v[112:115]
v_mfma_f32_16x16x32_bf16 v[132:135], v[204:207], v[244:247], v[132:135]
s_add_u32 s50, s50, 1
s_cmp_lt_u32 s50, 16
s_cbranch_scc1 cB_loop
cB_done:
s_waitcnt vmcnt(0) lgkmcnt(0)
v_lshlrev_b32 v2, 4, v1
v_add_u32 v2, 110592, v2
s_mul_i32 s45, s42, 5120
v_add_u32 v3, s45, v2
s_xor_b32 s46, s42, 2
s_mul_i32 s46, s46, 5120
v_add_u32 v4, s46, v2
ds_write_b128 v3, v[116:119] offset:0
ds_write_b128 v3, v[120:123] offset:1024
ds_write_b128 v3, v[124:127] offset:2048
ds_write_b128 v3, v[128:131] offset:3072
ds_write_b128 v3, v[132:135] offset:4096
s_waitcnt lgkmcnt(0)
s_barrier
ds_read_b128 v[136:139], v4 offset:0
ds_read_b128 v[140:143], v4 offset:1024
ds_read_b128 v[144:147], v4 offset:2048
ds_read_b128 v[148:151], v4 offset:3072
ds_read_b128 v[152:155], v4 offset:4096
s_waitcnt lgkmcnt(0)
v_add_f32 v96, v96, v136
v_add_f32 v97, v97, v137
v_add_f32 v98, v98, v138
v_add_f32 v99, v99, v139
v_add_f32 v100, v100, v140
v_add_f32 v101, v101, v141
v_add_f32 v102, v102, v142
v_add_f32 v103, v103, v143
v_add_f32 v104, v104, v144
v_add_f32 v105, v105, v145
v_add_f32 v106, v106, v146
v_add_f32 v107, v107, v147
v_add_f32 v108, v108, v148
v_add_f32 v109, v109, v149
v_add_f32 v110, v110, v150
v_add_f32 v111, v111, v151
v_add_f32 v112, v112, v152
v_add_f32 v113, v113, v153
v_add_f32 v114, v114, v154
v_add_f32 v115, v115, v155
s_mul_i32 s45, s97, 2048
s_add_u32 s56, s45, s58
s_cmp_eq_u32 s58, 43008
s_cselect_b32 s57, 0, 255
s_cselect_b32 s59, 255, 0
s_add_u32 s58, s45, 43008
s_mov_b32 s62, 0xbdd2d3e8
v_mov_b32 v9, 0xc0135761
s_mov_b32 s46, 0
v_lshlrev_b32 v32, 16, v18
v_and_b32 v33, 0xffff0000, v18
v_lshlrev_b32 v34, 16, v19
v_and_b32 v35, 0xffff0000, v19
v_add_f32 v96, v96, v32
v_add_f32 v97, v97, v33
v_add_f32 v98, v98, v34
v_add_f32 v99, v99, v35
v_add_f32 v100, v100, v32
v_add_f32 v101, v101, v33
v_add_f32 v102, v102, v34
v_add_f32 v103, v103, v35
v_add_f32 v104, v104, v32
v_add_f32 v105, v105, v33
v_add_f32 v106, v106, v34
v_add_f32 v107, v107, v35
v_add_f32 v108, v108, v32
v_add_f32 v109, v109, v33
v_add_f32 v110, v110, v34
v_add_f32 v111, v111, v35
v_add_f32 v112, v112, v32
v_add_f32 v113, v113, v33
v_add_f32 v114, v114, v34
v_add_f32 v115, v115, v35
v_mul_f32 v48, v96, v96
v_mul_f32 v49, v97, v97
v_mul_f32 v50, v98, v98
v_mul_f32 v51, v99, v99
v_mul_f32 v52, v100, v100
v_mul_f32 v53, v101, v101
v_mul_f32 v54, v102, v102
v_mul_f32 v55, v103, v103
v_mul_f32 v56, v104, v104
v_mul_f32 v57, v105, v105
v_mul_f32 v58, v106, v106
v_mul_f32 v59, v107, v107
v_mul_f32 v60, v108, v108
v_mul_f32 v61, v109, v109
v_mul_f32 v62, v110, v110
v_mul_f32 v63, v111, v111
v_mul_f32 v64, v112, v112
v_mul_f32 v65, v113, v113
v_mul_f32 v66, v114, v114
v_mul_f32 v67, v115, v115
v_fma_f32 v48, v48, s62, v9
v_fma_f32 v49, v49, s62, v9
v_fma_f32 v50, v50, s62, v9
v_fma_f32 v51, v51, s62, v9
v_fma_f32 v52, v52, s62, v9
v_fma_f32 v53, v53, s62, v9
v_fma_f32 v54, v54, s62, v9
v_fma_f32 v55, v55, s62, v9
v_fma_f32 v56, v56, s62, v9
v_fma_f32 v57, v57, s62, v9
v_fma_f32 v58, v58, s62, v9
v_fma_f32 v59, v59, s62, v9
v_fma_f32 v60, v60, s62, v9
v_fma_f32 v61, v61, s62, v9
v_fma_f32 v62, v62, s62, v9
v_fma_f32 v63, v63, s62, v9
v_fma_f32 v64, v64, s62, v9
v_fma_f32 v65, v65, s62, v9
v_fma_f32 v66, v66, s62, v9
v_fma_f32 v67, v67, s62, v9
v_mul_f32 v48, v48, v96
v_mul_f32 v49, v49, v97
v_mul_f32 v50, v50, v98
v_mul_f32 v51, v51, v99
v_mul_f32 v52, v52, v100
v_mul_f32 v53, v53, v101
v_mul_f32 v54, v54, v102
v_mul_f32 v55, v55, v103
v_mul_f32 v56, v56, v104
v_mul_f32 v57, v57, v105
v_mul_f32 v58, v58, v106
v_mul_f32 v59, v59, v107
v_mul_f32 v60, v60, v108
v_mul_f32 v61, v61, v109
v_mul_f32 v62, v62, v110
v_mul_f32 v63, v63, v111
v_mul_f32 v64, v64, v112
v_mul_f32 v65, v65, v113
v_mul_f32 v66, v66, v114
v_mul_f32 v67, v67, v115
v_exp_f32 v48, v48
v_exp_f32 v49, v49
v_exp_f32 v50, v50
v_exp_f32 v51, v51
v_exp_f32 v52, v52
v_exp_f32 v53, v53
v_exp_f32 v54, v54
v_exp_f32 v55, v55
v_exp_f32 v56, v56
v_exp_f32 v57, v57
v_exp_f32 v58, v58
v_exp_f32 v59, v59
v_exp_f32 v60, v60
v_exp_f32 v61, v61
v_exp_f32 v62, v62
v_exp_f32 v63, v63
v_exp_f32 v64, v64
v_exp_f32 v65, v65
v_exp_f32 v66, v66
v_exp_f32 v67, v67
v_add_f32 v48, 1.0, v48
v_add_f32 v49, 1.0, v49
v_add_f32 v50, 1.0, v50
v_add_f32 v51, 1.0, v51
v_add_f32 v52, 1.0, v52
v_add_f32 v53, 1.0, v53
v_add_f32 v54, 1.0, v54
v_add_f32 v55, 1.0, v55
v_add_f32 v56, 1.0, v56
v_add_f32 v57, 1.0, v57
v_add_f32 v58, 1.0, v58
v_add_f32 v59, 1.0, v59
v_add_f32 v60, 1.0, v60
v_add_f32 v61, 1.0, v61
v_add_f32 v62, 1.0, v62
v_add_f32 v63, 1.0, v63
v_add_f32 v64, 1.0, v64
v_add_f32 v65, 1.0, v65
v_add_f32 v66, 1.0, v66
v_add_f32 v67, 1.0, v67
v_rcp_f32 v48, v48
v_rcp_f32 v49, v49
v_rcp_f32 v50, v50
v_rcp_f32 v51, v51
v_mul_f32 v96, v96, v48
v_mul_f32 v97, v97, v49
v_mul_f32 v98, v98, v50
v_mul_f32 v99, v99, v51
v_cvt_pk_bf16_f32 v70, v96, v97
v_cvt_pk_bf16_f32 v71, v98, v99
ds_write_b64 v16, v[70:71] offset:0
v_rcp_f32 v52, v52
v_rcp_f32 v53, v53
v_rcp_f32 v54, v54
v_rcp_f32 v55, v55
v_mul_f32 v100, v100, v52
v_mul_f32 v101, v101, v53
v_mul_f32 v102, v102, v54
v_mul_f32 v103, v103, v55
v_cvt_pk_bf16_f32 v72, v100, v101
v_cvt_pk_bf16_f32 v73, v102, v103
ds_write_b64 v16, v[72:73] offset:2304
v_rcp_f32 v56, v56
v_rcp_f32 v57, v57
v_rcp_f32 v58, v58
v_rcp_f32 v59, v59
v_mul_f32 v104, v104, v56
v_mul_f32 v105, v105, v57
v_mul_f32 v106, v106, v58
v_mul_f32 v107, v107, v59
v_cvt_pk_bf16_f32 v74, v104, v105
v_cvt_pk_bf16_f32 v75, v106, v107
ds_write_b64 v16, v[74:75] offset:4608
v_rcp_f32 v60, v60
v_rcp_f32 v61, v61
v_rcp_f32 v62, v62
v_rcp_f32 v63, v63
v_mul_f32 v108, v108, v60
v_mul_f32 v109, v109, v61
v_mul_f32 v110, v110, v62
v_mul_f32 v111, v111, v63
v_cvt_pk_bf16_f32 v76, v108, v109
v_cvt_pk_bf16_f32 v77, v110, v111
ds_write_b64 v16, v[76:77] offset:6912
v_rcp_f32 v64, v64
v_rcp_f32 v65, v65
v_rcp_f32 v66, v66
v_rcp_f32 v67, v67
v_mul_f32 v112, v112, v64
v_mul_f32 v113, v113, v65
v_mul_f32 v114, v114, v66
v_mul_f32 v115, v115, v67
v_cvt_pk_bf16_f32 v78, v112, v113
v_cvt_pk_bf16_f32 v79, v114, v115
ds_write_b64 v16, v[78:79] offset:9216
s_waitcnt lgkmcnt(0)
s_barrier
ds_read_b128 v[48:51], v14 offset:0
ds_read_b128 v[52:55], v14 offset:4608
ds_read_b128 v[56:59], v14 offset:9216
s_waitcnt lgkmcnt(2)
buffer_store_dwordx4 v[48:51], v15, s[24:27], s46 offen sc1
s_add_u32 s46, s46, 151552
s_waitcnt lgkmcnt(1)
buffer_store_dwordx4 v[52:55], v15, s[24:27], s46 offen sc1
s_add_u32 s46, s46, 151552
s_waitcnt lgkmcnt(0)
buffer_store_dwordx4 v[56:59], v17, s[24:27], s46 offen sc1
s_add_u32 s46, s46, 151552
cC:
s_and_b32 s45, s42, 1
s_lshl_b32 s45, s45, 1
s_lshr_b32 s46, s42, 1
s_or_b32 s45, s45, s46
s_mul_i32 s46, s46, 18432
v_lshrrev_b32 v2, 4, v1
v_bfe_u32 v3, v1, 2, 2
v_and_b32 v4, 3, v1
v_lshl_add_u32 v5, v2, 3, v3
v_lshlrev_b32 v5, 7, v5
v_lshl_add_u32 v5, v4, 3, v5
v_add_u32 v5, s46, v5
v_lshrrev_b32 v6, 1, v3
v_and_b32 v7, 1, v2
v_lshl_or_b32 v6, v7, 1, v6
v_xor_b32 v6, s45, v6
v_lshl_add_u32 v20, v6, 5, v5
v_xor_b32 v6, 1, v6
v_lshl_add_u32 v21, v6, 5, v5
s_add_u32 s46, s46, 8192
v_and_b32 v3, 15, v1
v_lshrrev_b32 v4, 1, v3
v_xor_b32 v4, v4, v2
v_lshlrev_b32 v5, 7, v3
v_add_u32 v5, s46, v5
v_lshl_add_u32 v22, v4, 4, v5
v_xor_b32 v4, 4, v4
v_lshl_add_u32 v23, v4, 4, v5
v_mov_b32 v96, 0
v_mov_b32 v97, 0
v_mov_b32 v98, 0
v_mov_b32 v99, 0
v_mov_b32 v100, 0
v_mov_b32 v101, 0
v_mov_b32 v102, 0
v_mov_b32 v103, 0
v_mov_b32 v104, 0
v_mov_b32 v105, 0
v_mov_b32 v106, 0
v_mov_b32 v107, 0
v_mov_b32 v108, 0
v_mov_b32 v109, 0
v_mov_b32 v110, 0
v_mov_b32 v111, 0
v_mov_b32 v112, 0
v_mov_b32 v113, 0
v_mov_b32 v114, 0
v_mov_b32 v115, 0
v_mov_b32 v116, 0
v_mov_b32 v117, 0
v_mov_b32 v118, 0
v_mov_b32 v119, 0
v_mov_b32 v120, 0
v_mov_b32 v121, 0
v_mov_b32 v122, 0
v_mov_b32 v123, 0
v_mov_b32 v124, 0
v_mov_b32 v125, 0
v_mov_b32 v126, 0
v_mov_b32 v127, 0
v_mov_b32 v128, 0
v_mov_b32 v129, 0
v_mov_b32 v130, 0
v_mov_b32 v131, 0
v_mov_b32 v132, 0
v_mov_b32 v133, 0
v_mov_b32 v134, 0
v_mov_b32 v135, 0
s_mov_b32 s54, 73728
s_mov_b32 s50, 0
s_mov_b32 s48, 110592
v_add_u32 v24, s54, v20
v_add_u32 v25, s54, v21
v_add_u32 v26, s54, v22
v_add_u32 v27, s54, v23
s_add_u32 s54, s54, 36864
s_cmp_ge_u32 s54, s48
s_cselect_b32 s54, 0, s54
s_cmp_eq_u32 s57, 0
s_cbranch_scc1 cC_p0
s_waitcnt vmcnt(0)
cC_p0:
s_barrier
s_cbranch_scc1 cC_np
s_cmp_lg_u32 s42, 0
s_cbranch_scc1 cC_np
s_add_u32 s8, s14, 15728640
s_addc_u32 s9, s15, 0
s_mov_b32 s10, 65536
s_mov_b32 s11, 0x00020000
v_mul_u32_u24 v2, 256, v1
v_mov_b32 v3, s61
s_mov_b32 exec_lo, s57
s_mov_b32 exec_hi, 0
buffer_atomic_add v3, v2, s[8:11], s56 offen sc1
s_mov_b64 exec, -1
cC_np:
s_mov_b32 s24, s92
s_mov_b32 s25, s93
s_mov_b32 s26, 2621440
s_mov_b32 s27, 0x00020000
s_mov_b32 s28, s4
s_mov_b32 s29, s5
s_mov_b32 s30, 2621440
s_mov_b32 s31, 0x00020000
s_mov_b32 s32, s90
s_mov_b32 s33, s91
s_mov_b32 s34, 4096
s_mov_b32 s35, 0x00020000
s_lshl_b32 s45, s40, 2
s_and_b32 s46, s41, 3
s_add_u32 s45, s45, s46
s_lshl_b32 s45, s45, 6
s_and_b32 s46, s42, 1
s_lshl_b32 s46, s46, 5
s_add_u32 s45, s45, s46
s_lshr_b32 s46, s42, 1
s_lshl_b32 s46, s46, 4
s_add_u32 s45, s45, s46
v_and_b32 v2, 15, v1
v_add_u32 v2, s45, v2
v_lshlrev_b32 v3, 1, v2
v_mul_u32_u24 v16, 1280, v2
v_lshrrev_b32 v4, 4, v1
v_lshl_add_u32 v16, v4, 3, v16
s_lshr_b32 s45, s41, 2
s_mul_i32 s45, s45, 160
v_add_u32 v16, s45, v16
buffer_load_dwordx2 v[82:83], v16, s[28:31], 0 offen offset:0
buffer_load_dwordx2 v[84:85], v16, s[28:31], 0 offen offset:32
buffer_load_dwordx2 v[86:87], v16, s[28:31], 0 offen offset:64
buffer_load_dwordx2 v[88:89], v16, s[28:31], 0 offen offset:96
buffer_load_dwordx2 v[90:91], v16, s[28:31], 0 offen offset:128
buffer_load_ushort v92, v3, s[32:35], 0 offen
s_cmp_lg_u32 s98, 3
s_cbranch_scc1 cC_nx
s_barrier
cC_nx:
s_cmp_lg_u32 s59, 0
s_cselect_b32 s60, 1, 0
s_cmp_eq_u32 s98, 1
s_cselect_b32 s60, 1, s60
s_barrier
s_barrier
ds_read_b64_tr_b16 v[136:137], v24 offset:0
ds_read_b64_tr_b16 v[138:139], v24 offset:512
ds_read_b64_tr_b16 v[140:141], v25 offset:0
ds_read_b64_tr_b16 v[142:143], v25 offset:512
ds_read_b128 v[152:155], v26 offset:0
ds_read_b128 v[156:159], v26 offset:2048
ds_read_b128 v[160:163], v26 offset:4096
ds_read_b128 v[164:167], v26 offset:6144
ds_read_b128 v[168:171], v26 offset:8192
ds_read_b64_tr_b16 v[144:145], v24 offset:4096
ds_read_b64_tr_b16 v[146:147], v24 offset:4608
ds_read_b64_tr_b16 v[148:149], v25 offset:4096
ds_read_b64_tr_b16 v[150:151], v25 offset:4608
ds_read_b128 v[172:175], v27 offset:0
ds_read_b128 v[176:179], v27 offset:2048
ds_read_b128 v[180:183], v27 offset:4096
ds_read_b128 v[184:187], v27 offset:6144
ds_read_b128 v[188:191], v27 offset:8192
v_add_u32 v24, s54, v20
v_add_u32 v25, s54, v21
v_add_u32 v26, s54, v22
v_add_u32 v27, s54, v23
s_add_u32 s54, s54, 36864
s_cmp_ge_u32 s54, s48
s_cselect_b32 s54, 0, s54
cC_loop:
s_waitcnt lgkmcnt(0)
s_barrier
v_mfma_f32_16x16x32_bf16 v[96:99], v[152:155], v[136:139], v[96:99]
ds_read_b64_tr_b16 v[192:193], v24 offset:0
ds_read_b64_tr_b16 v[194:195], v24 offset:512
v_mfma_f32_16x16x32_bf16 v[116:119], v[152:155], v[140:143], v[116:119]
ds_read_b64_tr_b16 v[196:197], v25 offset:0
v_mfma_f32_16x16x32_bf16 v[100:103], v[156:159], v[136:139], v[100:103]
ds_read_b64_tr_b16 v[198:199], v25 offset:512
ds_read_b128 v[208:211], v26 offset:0
v_mfma_f32_16x16x32_bf16 v[120:123], v[156:159], v[140:143], v[120:123]
ds_read_b128 v[212:215], v26 offset:2048
v_mfma_f32_16x16x32_bf16 v[104:107], v[160:163], v[136:139], v[104:107]
ds_read_b128 v[216:219], v26 offset:4096
ds_read_b128 v[220:223], v26 offset:6144
v_mfma_f32_16x16x32_bf16 v[124:127], v[160:163], v[140:143], v[124:127]
ds_read_b128 v[224:227], v26 offset:8192
v_mfma_f32_16x16x32_bf16 v[108:111], v[164:167], v[136:139], v[108:111]
ds_read_b64_tr_b16 v[200:201], v24 offset:4096
ds_read_b64_tr_b16 v[202:203], v24 offset:4608
v_mfma_f32_16x16x32_bf16 v[128:131], v[164:167], v[140:143], v[128:131]
ds_read_b64_tr_b16 v[204:205], v25 offset:4096
v_mfma_f32_16x16x32_bf16 v[112:115], v[168:171], v[136:139], v[112:115]
ds_read_b64_tr_b16 v[206:207], v25 offset:4608
ds_read_b128 v[228:231], v27 offset:0
v_mfma_f32_16x16x32_bf16 v[132:135], v[168:171], v[140:143], v[132:135]
ds_read_b128 v[232:235], v27 offset:2048
v_mfma_f32_16x16x32_bf16 v[96:99], v[172:175], v[144:147], v[96:99]
ds_read_b128 v[236:239], v27 offset:4096
ds_read_b128 v[240:243], v27 offset:6144
v_mfma_f32_16x16x32_bf16 v[116:119], v[172:175], v[148:151], v[116:119]
ds_read_b128 v[244:247], v27 offset:8192
v_mfma_f32_16x16x32_bf16 v[100:103], v[176:179], v[144:147], v[100:103]
v_mfma_f32_16x16x32_bf16 v[120:123], v[176:179], v[148:151], v[120:123]
v_mfma_f32_16x16x32_bf16 v[104:107], v[180:183], v[144:147], v[104:107]
v_mfma_f32_16x16x32_bf16 v[124:127], v[180:183], v[148:151], v[124:127]
v_mfma_f32_16x16x32_bf16 v[108:111], v[184:187], v[144:147], v[108:111]
v_add_u32 v24, s54, v20
v_add_u32 v25, s54, v21
v_add_u32 v26, s54, v22
v_add_u32 v27, s54, v23
s_add_u32 s54, s54, 36864
s_cmp_ge_u32 s54, s48
s_cselect_b32 s54, 0, s54
v_mfma_f32_16x16x32_bf16 v[128:131], v[184:187], v[148:151], v[128:131]
v_mfma_f32_16x16x32_bf16 v[112:115], v[188:191], v[144:147], v[112:115]
v_mfma_f32_16x16x32_bf16 v[132:135], v[188:191], v[148:151], v[132:135]
s_add_u32 s50, s50, 1
s_cmp_ge_u32 s50, 19
s_cbranch_scc1 cC_done
s_cmp_eq_u32 s50, s60
s_cbranch_scc1 cC_def
cCd_np:
s_waitcnt lgkmcnt(0)
s_barrier
v_mfma_f32_16x16x32_bf16 v[96:99], v[208:211], v[192:195], v[96:99]
ds_read_b64_tr_b16 v[136:137], v24 offset:0
ds_read_b64_tr_b16 v[138:139], v24 offset:512
v_mfma_f32_16x16x32_bf16 v[116:119], v[208:211], v[196:199], v[116:119]
ds_read_b64_tr_b16 v[140:141], v25 offset:0
v_mfma_f32_16x16x32_bf16 v[100:103], v[212:215], v[192:195], v[100:103]
ds_read_b64_tr_b16 v[142:143], v25 offset:512
ds_read_b128 v[152:155], v26 offset:0
v_mfma_f32_16x16x32_bf16 v[120:123], v[212:215], v[196:199], v[120:123]
ds_read_b128 v[156:159], v26 offset:2048
v_mfma_f32_16x16x32_bf16 v[104:107], v[216:219], v[192:195], v[104:107]
ds_read_b128 v[160:163], v26 offset:4096
ds_read_b128 v[164:167], v26 offset:6144
v_mfma_f32_16x16x32_bf16 v[124:127], v[216:219], v[196:199], v[124:127]
ds_read_b128 v[168:171], v26 offset:8192
v_mfma_f32_16x16x32_bf16 v[108:111], v[220:223], v[192:195], v[108:111]
ds_read_b64_tr_b16 v[144:145], v24 offset:4096
ds_read_b64_tr_b16 v[146:147], v24 offset:4608
v_mfma_f32_16x16x32_bf16 v[128:131], v[220:223], v[196:199], v[128:131]
ds_read_b64_tr_b16 v[148:149], v25 offset:4096
v_mfma_f32_16x16x32_bf16 v[112:115], v[224:227], v[192:195], v[112:115]
ds_read_b64_tr_b16 v[150:151], v25 offset:4608
ds_read_b128 v[172:175], v27 offset:0
v_mfma_f32_16x16x32_bf16 v[132:135], v[224:227], v[196:199], v[132:135]
ds_read_b128 v[176:179], v27 offset:2048
v_mfma_f32_16x16x32_bf16 v[96:99], v[228:231], v[200:203], v[96:99]
ds_read_b128 v[180:183], v27 offset:4096
ds_read_b128 v[184:187], v27 offset:6144
v_mfma_f32_16x16x32_bf16 v[116:119], v[228:231], v[204:207], v[116:119]
ds_read_b128 v[188:191], v27 offset:8192
v_mfma_f32_16x16x32_bf16 v[100:103], v[232:235], v[200:203], v[100:103]
v_mfma_f32_16x16x32_bf16 v[120:123], v[232:235], v[204:207], v[120:123]
v_mfma_f32_16x16x32_bf16 v[104:107], v[236:239], v[200:203], v[104:107]
v_mfma_f32_16x16x32_bf16 v[124:127], v[236:239], v[204:207], v[124:127]
v_mfma_f32_16x16x32_bf16 v[108:111], v[240:243], v[200:203], v[108:111]
v_add_u32 v24, s54, v20
v_add_u32 v25, s54, v21
v_add_u32 v26, s54, v22
v_add_u32 v27, s54, v23
s_add_u32 s54, s54, 36864
s_cmp_ge_u32 s54, s48
s_cselect_b32 s54, 0, s54
v_mfma_f32_16x16x32_bf16 v[128:131], v[240:243], v[204:207], v[128:131]
v_mfma_f32_16x16x32_bf16 v[112:115], v[244:247], v[200:203], v[112:115]
v_mfma_f32_16x16x32_bf16 v[132:135], v[244:247], v[204:207], v[132:135]
s_add_u32 s50, s50, 1
s_cmp_lt_u32 s50, 19
s_cbranch_scc1 cC_loop
cC_done:
s_waitcnt vmcnt(0) lgkmcnt(0)
v_lshlrev_b32 v2, 4, v1
v_add_u32 v2, 110592, v2
s_mul_i32 s45, s42, 5120
v_add_u32 v3, s45, v2
s_xor_b32 s46, s42, 2
s_mul_i32 s46, s46, 5120
v_add_u32 v4, s46, v2
ds_write_b128 v3, v[116:119] offset:0
ds_write_b128 v3, v[120:123] offset:1024
ds_write_b128 v3, v[124:127] offset:2048
ds_write_b128 v3, v[128:131] offset:3072
ds_write_b128 v3, v[132:135] offset:4096
s_waitcnt lgkmcnt(0)
s_barrier
ds_read_b128 v[136:139], v4 offset:0
ds_read_b128 v[140:143], v4 offset:1024
ds_read_b128 v[144:147], v4 offset:2048
ds_read_b128 v[148:151], v4 offset:3072
ds_read_b128 v[152:155], v4 offset:4096
s_waitcnt lgkmcnt(0)
v_add_f32 v96, v96, v136
v_add_f32 v97, v97, v137
v_add_f32 v98, v98, v138
v_add_f32 v99, v99, v139
v_add_f32 v100, v100, v140
v_add_f32 v101, v101, v141
v_add_f32 v102, v102, v142
v_add_f32 v103, v103, v143
v_add_f32 v104, v104, v144
v_add_f32 v105, v105, v145
v_add_f32 v106, v106, v146
v_add_f32 v107, v107, v147
v_add_f32 v108, v108, v148
v_add_f32 v109, v109, v149
v_add_f32 v110, v110, v150
v_add_f32 v111, v111, v151
v_add_f32 v112, v112, v152
v_add_f32 v113, v113, v153
v_add_f32 v114, v114, v154
v_add_f32 v115, v115, v155
v_lshlrev_b32 v92, 16, v92
v_lshlrev_b32 v32, 16, v82
v_and_b32 v33, 0xffff0000, v82
v_lshlrev_b32 v34, 16, v83
v_and_b32 v35, 0xffff0000, v83
v_add_f32 v96, v96, v92
v_add_f32 v97, v97, v92
v_add_f32 v98, v98, v92
v_add_f32 v99, v99, v92
v_add_f32 v96, v96, v32
v_add_f32 v97, v97, v33
v_add_f32 v98, v98, v34
v_add_f32 v99, v99, v35
v_cvt_pk_bf16_f32 v82, v96, v97
v_cvt_pk_bf16_f32 v83, v98, v99
buffer_store_dwordx2 v[82:83], v16, s[24:27], 0 offen offset:0
v_lshlrev_b32 v36, 16, v84
v_and_b32 v37, 0xffff0000, v84
v_lshlrev_b32 v38, 16, v85
v_and_b32 v39, 0xffff0000, v85
v_add_f32 v100, v100, v92
v_add_f32 v101, v101, v92
v_add_f32 v102, v102, v92
v_add_f32 v103, v103, v92
v_add_f32 v100, v100, v36
v_add_f32 v101, v101, v37
v_add_f32 v102, v102, v38
v_add_f32 v103, v103, v39
v_cvt_pk_bf16_f32 v84, v100, v101
v_cvt_pk_bf16_f32 v85, v102, v103
buffer_store_dwordx2 v[84:85], v16, s[24:27], 0 offen offset:32
v_lshlrev_b32 v40, 16, v86
v_and_b32 v41, 0xffff0000, v86
v_lshlrev_b32 v42, 16, v87
v_and_b32 v43, 0xffff0000, v87
v_add_f32 v104, v104, v92
v_add_f32 v105, v105, v92
v_add_f32 v106, v106, v92
v_add_f32 v107, v107, v92
v_add_f32 v104, v104, v40
v_add_f32 v105, v105, v41
v_add_f32 v106, v106, v42
v_add_f32 v107, v107, v43
v_cvt_pk_bf16_f32 v86, v104, v105
v_cvt_pk_bf16_f32 v87, v106, v107
buffer_store_dwordx2 v[86:87], v16, s[24:27], 0 offen offset:64
v_lshlrev_b32 v44, 16, v88
v_and_b32 v45, 0xffff0000, v88
v_lshlrev_b32 v46, 16, v89
v_and_b32 v47, 0xffff0000, v89
v_add_f32 v108, v108, v92
v_add_f32 v109, v109, v92
v_add_f32 v110, v110, v92
v_add_f32 v111, v111, v92
v_add_f32 v108, v108, v44
v_add_f32 v109, v109, v45
v_add_f32 v110, v110, v46
v_add_f32 v111, v111, v47
v_cvt_pk_bf16_f32 v88, v108, v109
v_cvt_pk_bf16_f32 v89, v110, v111
buffer_store_dwordx2 v[88:89], v16, s[24:27], 0 offen offset:96
v_lshlrev_b32 v48, 16, v90
v_and_b32 v49, 0xffff0000, v90
v_lshlrev_b32 v50, 16, v91
v_and_b32 v51, 0xffff0000, v91
v_add_f32 v112, v112, v92
v_add_f32 v113, v113, v92
v_add_f32 v114, v114, v92
v_add_f32 v115, v115, v92
v_add_f32 v112, v112, v48
v_add_f32 v113, v113, v49
v_add_f32 v114, v114, v50
v_add_f32 v115, v115, v51
v_cvt_pk_bf16_f32 v90, v112, v113
v_cvt_pk_bf16_f32 v91, v114, v115
buffer_store_dwordx2 v[90:91], v16, s[24:27], 0 offen offset:128
k_end:
s_endpgm
cC_def:
s_waitcnt vmcnt(0)
s_add_u32 s8, s14, 15728640
s_addc_u32 s9, s15, 0
s_mov_b32 s10, 65536
s_mov_b32 s11, 0x00020000
v_mul_u32_u24 v2, 256, v1
v_mov_b32 v3, s61
s_mov_b32 exec_lo, s59
s_mov_b32 exec_hi, 0
buffer_atomic_add v3, v2, s[8:11], s58 offen sc1
s_mov_b64 exec, -1
s_branch cCd_np
.section .rodata,"a"
.p2align 6
.amdhsa_kernel m_kernel
  .amdhsa_next_free_vgpr 256
  .amdhsa_next_free_sgpr 100
  .amdhsa_accum_offset 256
  .amdhsa_group_segment_fixed_size 0
  .amdhsa_kernarg_size 88
  .amdhsa_user_sgpr_count 2
  .amdhsa_user_sgpr_kernarg_segment_ptr 1
  .amdhsa_system_sgpr_workgroup_id_x 1
.end_amdhsa_kernel
```
